```python
import torch

def _softmax(x, axis=-1):
    return torch.softmax(x, dim=axis)

def _gelu(x):
    return torch.nn.functional.gelu(x, approximate='tanh')

def _silu(x):
    return torch.nn.functional.silu(x)

def _sigmoid(x):
    return torch.sigmoid(x)

def _layernorm(x, axis=-1, eps=1e-05):
    m = x.mean(dim=axis, keepdim=True)
    v = x.var(dim=axis, keepdim=True, unbiased=False)
    return (x - m) / torch.sqrt(v + eps)

def _scatter_add(tgt, idx, src, axis=0):
    return tgt.clone().index_add_(axis, idx, src)

def _segment_sum(src, seg, n):
    out = torch.zeros((n,) + src.shape[1:], dtype=src.dtype)
    return out.index_add_(0, seg, src)

def _pad(x, pw):
    flat = tuple((v for pair in reversed(pw) for v in pair))
    return torch.nn.functional.pad(x, flat)
kernel_name = 'adaLN_cond__sliding_block__geglu_ffn__prompt'

def setup_inputs():

    _w = lambda a: (lambda t: t.to(torch.bfloat16) if t.is_floating_point() else t)(torch.as_tensor(a))

    def _A_setup():
        B, S, D = (1, 2048, 512)
        return {'x': _w((lambda *s: torch.randn(*s, dtype=torch.bfloat16) * 0.05)(B, S, D)), 'wqkv': _w((lambda *s: torch.randn(*s, dtype=torch.bfloat16) * 0.05)(D, 3 * D)), 'wo': _w((lambda *s: torch.randn(*s, dtype=torch.bfloat16) * 0.05)(D, D))}
    _A_in = _A_setup()

    def _B_setup():
        B, S, D, F = (1, 2048, 512, 1792)
        return {'x': _w((lambda *s: torch.randn(*s, dtype=torch.bfloat16) * 0.05)(B, S, D)), 'w_gate': _w((lambda *s: torch.randn(*s, dtype=torch.bfloat16) * 0.05)(D, F)), 'w_up': _w((lambda *s: torch.randn(*s, dtype=torch.bfloat16) * 0.05)(D, F)), 'w_down': _w((lambda *s: torch.randn(*s, dtype=torch.bfloat16) * 0.05)(F, D))}
    _B_in = _B_setup()
    return {'A_x': _A_in['x'], 'A_wqkv': _A_in['wqkv'], 'A_wo': _A_in['wo'], 'B_x': _B_in['x'], 'B_w_gate': _B_in['w_gate'], 'B_w_up': _B_in['w_up'], 'B_w_down': _B_in['w_down'], 'c': _w((lambda *s: torch.randn(*s, dtype=torch.bfloat16) * 0.1)(1, 512) * 8.0), 'w_mod': _w((lambda *s: torch.randn(*s, dtype=torch.bfloat16) * 0.1)(512, 6 * 512) * 512 ** (-0.5) * 8.0)}

def reference(A_x, A_wqkv, A_wo, B_x, B_w_gate, B_w_up, B_w_down, c, w_mod):

    def _A_ref(x, wqkv, wo):
        B, S, D = x.shape
        H = 32
        Dh = D // H
        W = 256
        qkv = (lambda x, *d: x.permute(*d))((x @ wqkv).reshape(B, S, 3, H, Dh), 2, 0, 3, 1, 4)
        q, k, v = (qkv[0], qkv[1], qkv[2])
        scores = torch.einsum('bhqd,bhkd->bhqk', q, k) * Dh ** (-0.5)
        idx = torch.arange(S)
        mask = (idx[:, None] - idx[None, :] >= 0) & (idx[:, None] - idx[None, :] < W)
        scores = torch.where(mask[None, None], scores, -1000000000.0)
        p = _softmax(scores, axis=-1)
        o = torch.einsum('bhqk,bhkd->bhqd', p, v)
        return (lambda x, *d: x.permute(*d))(o, 0, 2, 1, 3).reshape(B, S, D) @ wo

    def _B_ref(x, w_gate, w_up, w_down):
        return _gelu(x @ w_gate) * (x @ w_up) @ w_down
    x = A_x
    mod = (_silu(c) @ w_mod).reshape(c.shape[0], 6, 1, -1)
    sa, ca, ga, sb, cb, gb = (mod[:, 0].clone(), mod[:, 1].clone(), mod[:, 2].clone(), mod[:, 3].clone(), mod[:, 4].clone(), mod[:, 5].clone())
    h = _layernorm(x, axis=-1) * (1 + ca) + sa
    x = x + ga * _A_ref(h, A_wqkv, A_wo)
    h = _layernorm(x, axis=-1) * (1 + cb) + sb
    x = x + gb * _B_ref(h, B_w_gate, B_w_up, B_w_down)
    return x
```

```asm
; @launch kernel=k0_mod_kernel grid=(256,1,1) block=(256,1,1) lds=34048
; @launch kernel=k1_qkv_kernel grid=(256,1,1) block=(512,1,1) lds=159744
; @launch kernel=k2_attn_kernel grid=(256,1,1) block=(512,1,1) lds=65536
; @launch kernel=k3_wo_kernel grid=(256,1,1) block=(256,1,1) lds=50176
; @launch kernel=k4_ffn1_kernel grid=(256,1,1) block=(512,1,1) lds=163840
; @launch kernel=k5_down_kernel grid=(256,1,1) block=(256,1,1) lds=50176
.amdgcn_target "amdgcn-amd-amdhsa--gfx950"
.text
.globl k0_mod_kernel
.p2align 8
.type k0_mod_kernel,@function
k0_mod_kernel:
    s_cmp_ge_u32 s2, 256
    s_cbranch_scc1 L_end_k0_mod_kernel
    s_load_dwordx16 s[16:31], s[0:1], 0
    s_load_dwordx8 s[32:39], s[0:1], 64
    v_and_b32 v1, 63, v0
    v_lshrrev_b32 v2, 6, v0
    s_nop 0
    v_readfirstlane_b32 s3, v2
    s_and_b32 s4, s2, 7
    v_lshrrev_b32 v2, 3, v1
    v_and_b32 v3, 7, v1
    v_lshlrev_b32 v3, 4, v3
    v_mul_u32_u24 v4, 6144, v2
    v_add_u32 v4, v4, v3
    v_mul_u32_u24 v5, 3072, v2
    v_add_u32 v5, v5, v3
    v_lshlrev_b32 v7, 4, v1
    s_lshl_b32 s10, s4, 5
    s_lshr_b32 s11, s2, 3
    s_add_u32 s10, s10, s11
    s_lshl_b32 s10, s10, 3
    s_lshl_b32 s12, s3, 1
    s_add_u32 s12, s10, s12
    s_lshl_b32 s12, s12, 10
    s_min_u32 s5, s2, 191
    s_lshr_b32 s5, s5, 2
    s_and_b32 s6, s2, 3
    s_lshl_b32 s13, s6, 7
    s_lshl_b32 s14, s3, 5
    s_add_u32 s13, s13, s14
    v_and_b32 v6, 15, v1
    v_lshlrev_b32 v6, 2, v6
    s_lshl_b32 s15, s13, 1
    s_waitcnt lgkmcnt(0)
    s_mov_b32 s40, s38
    s_mov_b32 s41, s39
    s_mov_b32 s42, 34603008
    s_mov_b32 s43, 131072
    s_mov_b32 s44, s32
    s_mov_b32 s45, s33
    s_mov_b32 s46, 3145728
    s_mov_b32 s47, 131072
    s_mov_b32 s48, s18
    s_mov_b32 s49, s19
    s_mov_b32 s50, 1572864
    s_mov_b32 s51, 131072
    s_mov_b32 s52, s16
    s_mov_b32 s53, s17
    s_mov_b32 s54, 2097152
    s_mov_b32 s55, 131072
    s_mov_b32 s56, s30
    s_mov_b32 s57, s31
    s_mov_b32 s58, 1024
    s_mov_b32 s59, 131072
    buffer_load_dword v8, v6, s[56:59], s15 offen
    buffer_load_dwordx4 v[12:15], v7, s[52:55], s12 offen
    buffer_load_dwordx4 v[16:19], v7, s[52:55], s12 offen offset:1024
    s_mul_i32 s7, s13, 6144
    s_lshl_b32 s8, s5, 7
    s_add_u32 s7, s7, s8
    s_lshl_b32 s8, s3, 12
    s_add_u32 m0, s8, 0
    s_add_u32 s9, s7, 0
    buffer_load_dwordx4 v4, s[44:47], s9 offen lds
    s_add_u32 m0, s8, 1024
    s_add_u32 s9, s7, 49152
    buffer_load_dwordx4 v4, s[44:47], s9 offen lds
    s_add_u32 m0, s8, 2048
    s_add_u32 s9, s7, 98304
    buffer_load_dwordx4 v4, s[44:47], s9 offen lds
    s_add_u32 m0, s8, 3072
    s_add_u32 s9, s7, 147456
    buffer_load_dwordx4 v4, s[44:47], s9 offen lds
    s_min_u32 s14, s3, 2
    s_lshl_b32 s14, s14, 10
    s_mul_i32 s15, s11, 49152
    s_add_u32 s14, s14, s15
    s_lshl_b32 s15, s4, 7
    s_add_u32 s14, s14, s15
    s_lshl_b32 s60, s3, 11
    s_add_u32 m0, s60, 16384
    s_add_u32 s9, s14, 0
    buffer_load_dwordx4 v5, s[48:51], s9 offen lds
    s_add_u32 m0, s60, 17408
    s_add_u32 s9, s14, 24576
    buffer_load_dwordx4 v5, s[48:51], s9 offen lds
    s_getpc_b64 s[64:65]
L_pc_k0_mod_kernel:
    s_lshr_b32 s66, s2, 3
    s_mul_i32 s66, s66, 4
    s_add_u32 s66, s66, s3
    s_lshl_b32 s66, s66, 13
    v_lshlrev_b32 v21, 7, v1
    v_add_u32 v21, s66, v21
    v_min_u32 v21, k2_attn_kernel-k1_qkv_kernel-4, v21
    v_add_u32 v21, k1_qkv_kernel-L_pc_k0_mod_kernel, v21
    global_load_dword v27, v21, s[64:65]
    v_lshrrev_b32 v2, 4, v1
    v_bfe_u32 v3, v1, 2, 2
    v_and_b32 v9, 3, v1
    v_lshl_add_u32 v20, v2, 3, v3
    v_lshlrev_b32 v20, 7, v20
    v_lshl_add_u32 v20, v9, 3, v20
    v_add_u32 v20, s8, v20
    s_lshl_b32 s9, s3, 6
    s_add_u32 s9, s9, 32768
    v_lshl_add_u32 v22, v2, 4, s9
    v_add_u32 v23, s9, v6
    v_lshrrev_b32 v24, 5, v1
    v_lshl_add_u32 v25, v24, 3, v3
    v_lshlrev_b32 v25, 7, v25
    v_bfe_u32 v26, v1, 4, 1
    v_lshl_add_u32 v25, v26, 5, v25
    v_lshl_add_u32 v25, v9, 3, v25
    s_add_u32 s9, s60, 16384
    v_add_u32 v25, s9, v25
    s_waitcnt vmcnt(9)
    v_lshlrev_b32 v9, 16, v8
    v_and_b32 v10, 4294901760, v8
    s_mov_b32 s14, 3216550459
    v_mul_f32 v28, s14, v9
    v_mul_f32 v29, s14, v10
    v_exp_f32 v28, v28
    v_exp_f32 v29, v29
    v_add_f32 v28, 1.0, v28
    v_add_f32 v29, 1.0, v29
    v_rcp_f32 v28, v28
    v_rcp_f32 v29, v29
    v_mul_f32 v9, v9, v28
    v_mul_f32 v10, v10, v29
    v_cvt_pk_bf16_f32 v9, v9, v10
    ds_write_b32 v23, v9
    s_waitcnt vmcnt(7)
    v_lshlrev_b32 v64, 16, v12
    v_and_b32 v65, 4294901760, v12
    v_lshlrev_b32 v66, 16, v13
    v_and_b32 v67, 4294901760, v13
    v_lshlrev_b32 v68, 16, v14
    v_and_b32 v69, 4294901760, v14
    v_lshlrev_b32 v70, 16, v15
    v_and_b32 v71, 4294901760, v15
    v_lshlrev_b32 v72, 16, v16
    v_and_b32 v73, 4294901760, v16
    v_lshlrev_b32 v74, 16, v17
    v_and_b32 v75, 4294901760, v17
    v_lshlrev_b32 v76, 16, v18
    v_and_b32 v77, 4294901760, v18
    v_lshlrev_b32 v78, 16, v19
    v_and_b32 v79, 4294901760, v19
    s_waitcnt lgkmcnt(0)
    ds_read_b128 v[48:51], v22
    v_add_f32 v40, v64, v65
    v_add_f32 v40, v40, v66
    v_add_f32 v40, v40, v67
    v_add_f32 v40, v40, v68
    v_add_f32 v40, v40, v69
    v_add_f32 v40, v40, v70
    v_add_f32 v40, v40, v71
    v_add_f32 v41, v72, v73
    v_add_f32 v41, v41, v74
    v_add_f32 v41, v41, v75
    v_add_f32 v41, v41, v76
    v_add_f32 v41, v41, v77
    v_add_f32 v41, v41, v78
    v_add_f32 v41, v41, v79
    v_add_f32 v40, v40, v40 row_shr:1 row_mask:0xf bank_mask:0xf
    s_nop 0
    v_add_f32 v41, v41, v41 row_shr:1 row_mask:0xf bank_mask:0xf
    v_add_f32 v40, v40, v40 row_shr:2 row_mask:0xf bank_mask:0xf
    s_nop 0
    v_add_f32 v41, v41, v41 row_shr:2 row_mask:0xf bank_mask:0xf
    v_add_f32 v40, v40, v40 row_shr:4 row_mask:0xf bank_mask:0xf
    s_nop 0
    v_add_f32 v41, v41, v41 row_shr:4 row_mask:0xf bank_mask:0xf
    v_add_f32 v40, v40, v40 row_shr:8 row_mask:0xf bank_mask:0xf
    s_nop 0
    v_add_f32 v41, v41, v41 row_shr:8 row_mask:0xf bank_mask:0xf
    v_add_f32 v40, v40, v40 row_bcast:15 row_mask:0xa bank_mask:0xf
    s_nop 0
    v_add_f32 v41, v41, v41 row_bcast:15 row_mask:0xa bank_mask:0xf
    v_add_f32 v40, v40, v40 row_bcast:31 row_mask:0xc bank_mask:0xf
    s_nop 0
    v_add_f32 v41, v41, v41 row_bcast:31 row_mask:0xc bank_mask:0xf
    v_readlane_b32 s62, v40, 63
    v_readlane_b32 s63, v41, 63
    s_mov_b32 s14, 989855744
    v_mov_b32 v40, s62
    v_mul_f32 v40, s14, v40
    v_mov_b32 v41, s63
    v_mul_f32 v41, s14, v41
    v_sub_f32 v64, v64, v40
    v_sub_f32 v65, v65, v40
    v_sub_f32 v66, v66, v40
    v_sub_f32 v67, v67, v40
    v_sub_f32 v68, v68, v40
    v_sub_f32 v69, v69, v40
    v_sub_f32 v70, v70, v40
    v_sub_f32 v71, v71, v40
    v_sub_f32 v72, v72, v41
    v_sub_f32 v73, v73, v41
    v_sub_f32 v74, v74, v41
    v_sub_f32 v75, v75, v41
    v_sub_f32 v76, v76, v41
    v_sub_f32 v77, v77, v41
    v_sub_f32 v78, v78, v41
    v_sub_f32 v79, v79, v41
    v_mul_f32 v42, v64, v64
    v_fmac_f32 v42, v65, v65
    v_fmac_f32 v42, v66, v66
    v_fmac_f32 v42, v67, v67
    v_fmac_f32 v42, v68, v68
    v_fmac_f32 v42, v69, v69
    v_fmac_f32 v42, v70, v70
    v_fmac_f32 v42, v71, v71
    v_mul_f32 v43, v72, v72
    v_fmac_f32 v43, v73, v73
    v_fmac_f32 v43, v74, v74
    v_fmac_f32 v43, v75, v75
    v_fmac_f32 v43, v76, v76
    v_fmac_f32 v43, v77, v77
    v_fmac_f32 v43, v78, v78
    v_fmac_f32 v43, v79, v79
    v_add_f32 v42, v42, v42 row_shr:1 row_mask:0xf bank_mask:0xf
    s_nop 0
    v_add_f32 v43, v43, v43 row_shr:1 row_mask:0xf bank_mask:0xf
    v_add_f32 v42, v42, v42 row_shr:2 row_mask:0xf bank_mask:0xf
    s_nop 0
    v_add_f32 v43, v43, v43 row_shr:2 row_mask:0xf bank_mask:0xf
    v_add_f32 v42, v42, v42 row_shr:4 row_mask:0xf bank_mask:0xf
    s_nop 0
    v_add_f32 v43, v43, v43 row_shr:4 row_mask:0xf bank_mask:0xf
    v_add_f32 v42, v42, v42 row_shr:8 row_mask:0xf bank_mask:0xf
    s_nop 0
    v_add_f32 v43, v43, v43 row_shr:8 row_mask:0xf bank_mask:0xf
    v_add_f32 v42, v42, v42 row_bcast:15 row_mask:0xa bank_mask:0xf
    s_nop 0
    v_add_f32 v43, v43, v43 row_bcast:15 row_mask:0xa bank_mask:0xf
    v_add_f32 v42, v42, v42 row_bcast:31 row_mask:0xc bank_mask:0xf
    s_nop 0
    v_add_f32 v43, v43, v43 row_bcast:31 row_mask:0xc bank_mask:0xf
    v_readlane_b32 s62, v42, 63
    v_readlane_b32 s63, v43, 63
    s_mov_b32 s15, 925353388
    v_mov_b32 v42, s62
    v_mov_b32 v44, s15
    v_fma_f32 v42, v42, s14, v44
    v_rsq_f32 v42, v42
    v_mov_b32 v43, s63
    v_mov_b32 v44, s15
    v_fma_f32 v43, v43, s14, v44
    v_rsq_f32 v43, v43
    v_mul_f32 v64, v64, v42
    v_mul_f32 v65, v65, v42
    v_mul_f32 v66, v66, v42
    v_mul_f32 v67, v67, v42
    v_mul_f32 v68, v68, v42
    v_mul_f32 v69, v69, v42
    v_mul_f32 v70, v70, v42
    v_mul_f32 v71, v71, v42
    v_mul_f32 v72, v72, v43
    v_mul_f32 v73, v73, v43
    v_mul_f32 v74, v74, v43
    v_mul_f32 v75, v75, v43
    v_mul_f32 v76, v76, v43
    v_mul_f32 v77, v77, v43
    v_mul_f32 v78, v78, v43
    v_mul_f32 v79, v79, v43
    v_cvt_pk_bf16_f32 v12, v64, v65
    v_cvt_pk_bf16_f32 v13, v66, v67
    v_cvt_pk_bf16_f32 v14, v68, v69
    v_cvt_pk_bf16_f32 v15, v70, v71
    v_cvt_pk_bf16_f32 v16, v72, v73
    v_cvt_pk_bf16_f32 v17, v74, v75
    v_cvt_pk_bf16_f32 v18, v76, v77
    v_cvt_pk_bf16_f32 v19, v78, v79
    v_lshlrev_b32 v11, 7, v1
    s_lshl_b32 s9, s3, 5
    s_add_u32 s9, s9, 24576
    v_add_u32 v11, s9, v11
    ds_write_b128 v11, v[12:15]
    ds_write_b128 v11, v[16:19] offset:16
    s_waitcnt vmcnt(3)
    ds_read_b64_tr_b16 v[80:81], v20 offset:0
    ds_read_b64_tr_b16 v[82:83], v20 offset:512
    ds_read_b64_tr_b16 v[84:85], v20 offset:32
    ds_read_b64_tr_b16 v[86:87], v20 offset:544
    ds_read_b64_tr_b16 v[88:89], v20 offset:64
    ds_read_b64_tr_b16 v[90:91], v20 offset:576
    ds_read_b64_tr_b16 v[92:93], v20 offset:96
    ds_read_b64_tr_b16 v[94:95], v20 offset:608
    s_waitcnt lgkmcnt(6)
    v_mfma_f32_16x16x32_bf16 v[100:103], v[48:51], v[80:83], 0
    s_waitcnt lgkmcnt(4)
    v_mfma_f32_16x16x32_bf16 v[104:107], v[48:51], v[84:87], 0
    s_waitcnt lgkmcnt(2)
    v_mfma_f32_16x16x32_bf16 v[108:111], v[48:51], v[88:91], 0
    s_waitcnt lgkmcnt(0)
    v_mfma_f32_16x16x32_bf16 v[112:115], v[48:51], v[92:95], 0
    s_waitcnt vmcnt(1)
    ds_read_b64_tr_b16 v[52:53], v25 offset:0
    ds_read_b64_tr_b16 v[54:55], v25 offset:512
    ds_read_b64_tr_b16 v[56:57], v25 offset:64
    ds_read_b64_tr_b16 v[58:59], v25 offset:576
    s_lshl_b32 s9, s3, 8
    s_add_u32 s9, s9, 33024
    v_add_u32 v28, s9, v6
    ds_write_b32 v28, v100 offset:0
    ds_write_b32 v28, v104 offset:64
    ds_write_b32 v28, v108 offset:128
    ds_write_b32 v28, v112 offset:192
    s_mul_i32 s9, s4, 196608
    s_mul_i32 s14, s11, 3072
    s_add_u32 s9, s9, s14
    s_lshl_b32 s14, s3, 10
    s_add_u32 s9, s9, s14
    s_add_u32 s9, s9, 2097152
    s_add_u32 s14, s9, 98304
    s_waitcnt lgkmcnt(0)
    s_cmp_eq_u32 s3, 3
    s_cbranch_scc1 L_k0_now
    buffer_store_dwordx4 v[52:55], v7, s[40:43], s9 offen sc1
    buffer_store_dwordx4 v[56:59], v7, s[40:43], s14 offen sc1
    s_nop 1
L_k0_now:
    s_barrier
    s_add_u32 s9, s60, 24576
    v_add_u32 v11, s9, v7
    ds_read_b128 v[12:15], v11
    ds_read_b128 v[16:19], v11 offset:1024
    v_lshlrev_b32 v29, 2, v1
    ds_read_b32 v30, v29 offset:33024
    ds_read_b32 v31, v29 offset:33280
    ds_read_b32 v32, v29 offset:33536
    ds_read_b32 v33, v29 offset:33792
    s_lshr_b32 s12, s10, 5
    s_lshl_b32 s12, s12, 15
    s_and_b32 s14, s10, 31
    s_lshl_b32 s14, s14, 4
    s_add_u32 s12, s12, s14
    s_lshl_b32 s14, s3, 13
    s_add_u32 s12, s12, s14
    s_add_u32 s12, s12, 0
    s_add_u32 s14, s12, 4096
    v_lshrrev_b32 v11, 3, v1
    v_lshlrev_b32 v11, 9, v11
    v_and_b32 v10, 7, v1
    v_lshl_add_u32 v11, v10, 4, v11
    s_waitcnt lgkmcnt(4)
    buffer_store_dwordx4 v[12:15], v11, s[40:43], s12 offen sc1
    buffer_store_dwordx4 v[16:19], v11, s[40:43], s14 offen sc1
    s_cmp_lg_u32 s3, 3
    s_cbranch_scc1 L_k0_done
    s_cmp_ge_u32 s2, 192
    s_cbranch_scc1 L_k0_done
    s_waitcnt lgkmcnt(0)
    v_add_f32 v30, v30, v31
    v_add_f32 v32, v32, v33
    v_add_f32 v30, v30, v32
    s_mul_i32 s9, s6, 12288
    s_lshl_b32 s14, s5, 8
    s_add_u32 s9, s9, s14
    s_add_u32 s9, s9, 9961472
    buffer_store_dword v30, v29, s[40:43], s9 offen
L_k0_done:
L_end_k0_mod_kernel:
    s_endpgm

.globl k1_qkv_kernel
.p2align 8
.type k1_qkv_kernel,@function
k1_qkv_kernel:
    s_cmp_ge_u32 s2, 256
    s_cbranch_scc1 L_end_k1_qkv_kernel
    s_load_dwordx16 s[16:31], s[0:1], 0
    s_load_dwordx8 s[32:39], s[0:1], 64
    v_and_b32 v1, 63, v0
    v_lshrrev_b32 v2, 6, v0
    s_nop 0
    v_readfirstlane_b32 s3, v2
    s_bfe_u32 s4, s2, 131073
    s_lshl_b32 s4, s4, 2
    s_bfe_u32 s5, s2, 131075
    s_add_u32 s4, s4, s5
    s_and_b32 s5, s2, 1
    s_lshl_b32 s5, s5, 3
    s_lshr_b32 s62, s2, 5
    s_add_u32 s5, s5, s62
    s_and_b32 s61, s3, 3
    s_lshr_b32 s63, s3, 2
    s_lshl_b32 s6, s4, 2
    s_add_u32 s6, s6, s61
    v_lshlrev_b32 v2, 4, v1
    v_lshlrev_b32 v4, 3, v0
    s_lshl_b32 s8, s63, 4
    s_add_u32 s8, s8, s61
    s_mul_i32 s8, s8, 3072
    s_mul_i32 s7, s5, 98304
    s_add_u32 s7, s7, s8
    s_add_u32 s7, s7, 2097152
    s_lshl_b32 s9, s6, 15
    s_lshl_b32 s10, s63, 14
    s_add_u32 s9, s9, s10
    s_add_u32 s9, s9, 0
    s_waitcnt lgkmcnt(0)
    s_mov_b32 s40, s38
    s_mov_b32 s41, s39
    s_mov_b32 s42, 34603008
    s_mov_b32 s43, 131072
    s_cmp_ge_u32 s2, 4
    s_cbranch_scc1 L_k1_nosj
    s_lshl_b32 s10, s2, 11
    s_add_u32 s10, s10, 9965568
    v_lshlrev_b32 v3, 2, v0
    s_add_u32 s11, s10, 0
    buffer_load_dword v192, v3, s[40:43], s11 offen
    s_add_u32 s11, s10, 12288
    buffer_load_dword v193, v3, s[40:43], s11 offen
    s_add_u32 s11, s10, 24576
    buffer_load_dword v194, v3, s[40:43], s11 offen
    s_add_u32 s11, s10, 36864
    buffer_load_dword v195, v3, s[40:43], s11 offen
L_k1_nosj:
    s_mov_b32 s10, 9961472
    buffer_load_dwordx2 v[16:17], v4, s[40:43], s10 offen
    s_mov_b32 s10, 9973760
    buffer_load_dwordx2 v[18:19], v4, s[40:43], s10 offen
    s_mov_b32 s10, 9986048
    buffer_load_dwordx2 v[20:21], v4, s[40:43], s10 offen
    s_mov_b32 s10, 9998336
    buffer_load_dwordx2 v[22:23], v4, s[40:43], s10 offen
    s_add_u32 s10, s7, 0
    s_add_u32 m0, s8, 0
    s_nop 0
    buffer_load_dwordx4 v2, s[40:43], s10 offen offset:0 lds
    s_add_u32 m0, s8, 0
    s_nop 0
    buffer_load_dwordx4 v2, s[40:43], s10 offen offset:1024 lds
    s_add_u32 m0, s8, 0
    s_nop 0
    buffer_load_dwordx4 v2, s[40:43], s10 offen offset:2048 lds
    s_add_u32 s11, s9, 0
    buffer_load_dwordx4 v[64:67], v2, s[40:43], s11 offen offset:0
    buffer_load_dwordx4 v[68:71], v2, s[40:43], s11 offen offset:1024
    s_mul_i32 s10, s63, 49152
    v_add_u32 v3, s10, v2
    v_lshrrev_b32 v5, 5, v1
    v_lshlrev_b32 v5, 5, v5
    s_lshl_b32 s10, s63, 10
    s_add_u32 s10, s10, 98304
    v_add_u32 v5, s10, v5
    v_add_u32 v6, 98304, v4
    s_waitcnt vmcnt(5)
    v_add_f32 v16, v16, v18
    v_add_f32 v20, v20, v22
    v_add_f32 v17, v17, v19
    v_add_f32 v21, v21, v23
    v_add_f32 v16, v16, v20
    v_add_f32 v17, v17, v21
    v_cvt_pk_bf16_f32 v18, v16, v17
    v_lshlrev_b32 v16, 16, v18
    v_and_b32 v17, 4294901760, v18
    s_cmp_eq_u32 s63, 0
    s_cbranch_scc1 L_k1_issa
    v_add_f32 v16, 1.0, v16
    v_add_f32 v17, 1.0, v17
    v_cvt_pk_bf16_f32 v18, v16, v17
    v_lshlrev_b32 v16, 16, v18
    v_and_b32 v17, 4294901760, v18
    s_nop 2
L_k1_issa:
    ds_write_b64 v6, v[16:17]
    buffer_load_dwordx4 v[72:75], v2, s[40:43], s11 offen offset:2048
    buffer_load_dwordx4 v[76:79], v2, s[40:43], s11 offen offset:3072
    s_add_u32 s10, s7, 12288
    s_add_u32 m0, s8, 12288
    s_nop 0
    buffer_load_dwordx4 v2, s[40:43], s10 offen offset:0 lds
    s_add_u32 m0, s8, 12288
    s_nop 0
    buffer_load_dwordx4 v2, s[40:43], s10 offen offset:1024 lds
    s_add_u32 m0, s8, 12288
    s_nop 0
    buffer_load_dwordx4 v2, s[40:43], s10 offen offset:2048 lds
    s_waitcnt lgkmcnt(0)
    s_waitcnt vmcnt(6)
    s_barrier
    ds_read_b128 v[128:131], v3 offset:0
    ds_read_b128 v[132:135], v3 offset:1024
    ds_read_b128 v[136:139], v3 offset:2048
    ds_read_b128 v[152:155], v5 offset:0
    ds_read_b128 v[156:159], v5 offset:16
    ds_read_b128 v[160:163], v5 offset:2048
    ds_read_b128 v[164:167], v5 offset:2064
    ds_read_b128 v[168:171], v5 offset:64
    ds_read_b128 v[172:175], v5 offset:80
    ds_read_b128 v[176:179], v5 offset:2112
    ds_read_b128 v[180:183], v5 offset:2128
    s_waitcnt lgkmcnt(4)
    v_lshlrev_b32 v184, 16, v64
    v_and_b32 v185, 4294901760, v64
    v_lshlrev_b32 v186, 16, v65
    v_and_b32 v187, 4294901760, v65
    v_lshlrev_b32 v188, 16, v66
    v_and_b32 v189, 4294901760, v66
    v_lshlrev_b32 v190, 16, v67
    v_and_b32 v191, 4294901760, v67
    v_fma_f32 v184, v184, v160, v152
    v_fma_f32 v185, v185, v161, v153
    v_fma_f32 v186, v186, v162, v154
    v_fma_f32 v187, v187, v163, v155
    v_fma_f32 v188, v188, v164, v156
    v_fma_f32 v189, v189, v165, v157
    v_fma_f32 v190, v190, v166, v158
    v_fma_f32 v191, v191, v167, v159
    v_cvt_pk_bf16_f32 v64, v184, v185
    v_cvt_pk_bf16_f32 v65, v186, v187
    v_cvt_pk_bf16_f32 v66, v188, v189
    v_cvt_pk_bf16_f32 v67, v190, v191
    s_waitcnt vmcnt(5)
    ds_read_b128 v[140:143], v3 offset:3072
    ds_read_b128 v[144:147], v3 offset:4096
    ds_read_b128 v[148:151], v3 offset:5120
    ds_read_b128 v[152:155], v5 offset:128
    ds_read_b128 v[156:159], v5 offset:144
    ds_read_b128 v[160:163], v5 offset:2176
    ds_read_b128 v[164:167], v5 offset:2192
    s_waitcnt lgkmcnt(7)
    v_mfma_f32_32x32x16_bf16 v[16:31], v[128:131], v[64:67], 0
    s_add_u32 s11, s9, 4096
    buffer_load_dwordx4 v[80:83], v2, s[40:43], s11 offen offset:0
    v_lshlrev_b32 v184, 16, v68
    v_and_b32 v185, 4294901760, v68
    v_lshlrev_b32 v186, 16, v69
    v_and_b32 v187, 4294901760, v69
    v_lshlrev_b32 v188, 16, v70
    v_and_b32 v189, 4294901760, v70
    v_lshlrev_b32 v190, 16, v71
    v_mfma_f32_32x32x16_bf16 v[32:47], v[132:135], v[64:67], 0
    buffer_load_dwordx4 v[84:87], v2, s[40:43], s11 offen offset:1024
    v_and_b32 v191, 4294901760, v71
    v_fma_f32 v184, v184, v176, v168
    v_fma_f32 v185, v185, v177, v169
    v_fma_f32 v186, v186, v178, v170
    v_fma_f32 v187, v187, v179, v171
    v_fma_f32 v188, v188, v180, v172
    v_fma_f32 v189, v189, v181, v173
    v_mfma_f32_32x32x16_bf16 v[48:63], v[64:67], v[136:139], 0
    v_fma_f32 v190, v190, v182, v174
    v_fma_f32 v191, v191, v183, v175
    v_cvt_pk_bf16_f32 v68, v184, v185
    v_cvt_pk_bf16_f32 v69, v186, v187
    v_cvt_pk_bf16_f32 v70, v188, v189
    v_cvt_pk_bf16_f32 v71, v190, v191
    s_waitcnt vmcnt(6)
    ds_read_b128 v[128:131], v3 offset:6144
    ds_read_b128 v[132:135], v3 offset:7168
    ds_read_b128 v[136:139], v3 offset:8192
    ds_read_b128 v[168:171], v5 offset:192
    ds_read_b128 v[172:175], v5 offset:208
    ds_read_b128 v[176:179], v5 offset:2240
    ds_read_b128 v[180:183], v5 offset:2256
    s_waitcnt lgkmcnt(7)
    v_mfma_f32_32x32x16_bf16 v[16:31], v[140:143], v[68:71], v[16:31]
    buffer_load_dwordx4 v[88:91], v2, s[40:43], s11 offen offset:2048
    v_lshlrev_b32 v184, 16, v72
    v_and_b32 v185, 4294901760, v72
    v_lshlrev_b32 v186, 16, v73
    v_and_b32 v187, 4294901760, v73
    v_lshlrev_b32 v188, 16, v74
    v_and_b32 v189, 4294901760, v74
    v_lshlrev_b32 v190, 16, v75
    v_mfma_f32_32x32x16_bf16 v[32:47], v[144:147], v[68:71], v[32:47]
    buffer_load_dwordx4 v[92:95], v2, s[40:43], s11 offen offset:3072
    v_and_b32 v191, 4294901760, v75
    v_fma_f32 v184, v184, v160, v152
    v_fma_f32 v185, v185, v161, v153
    v_fma_f32 v186, v186, v162, v154
    v_fma_f32 v187, v187, v163, v155
    v_fma_f32 v188, v188, v164, v156
    v_fma_f32 v189, v189, v165, v157
    v_mfma_f32_32x32x16_bf16 v[48:63], v[68:71], v[148:151], v[48:63]
    v_fma_f32 v190, v190, v166, v158
    v_fma_f32 v191, v191, v167, v159
    v_cvt_pk_bf16_f32 v72, v184, v185
    v_cvt_pk_bf16_f32 v73, v186, v187
    v_cvt_pk_bf16_f32 v74, v188, v189
    v_cvt_pk_bf16_f32 v75, v190, v191
    s_waitcnt vmcnt(7)
    ds_read_b128 v[140:143], v3 offset:9216
    ds_read_b128 v[144:147], v3 offset:10240
    ds_read_b128 v[148:151], v3 offset:11264
    ds_read_b128 v[152:155], v5 offset:256
    ds_read_b128 v[156:159], v5 offset:272
    ds_read_b128 v[160:163], v5 offset:2304
    ds_read_b128 v[164:167], v5 offset:2320
    s_waitcnt lgkmcnt(7)
    v_mfma_f32_32x32x16_bf16 v[16:31], v[128:131], v[72:75], v[16:31]
    s_add_u32 s10, s7, 24576
    s_add_u32 m0, s8, 24576
    s_nop 0
    buffer_load_dwordx4 v2, s[40:43], s10 offen offset:0 lds
    v_lshlrev_b32 v184, 16, v76
    v_and_b32 v185, 4294901760, v76
    v_lshlrev_b32 v186, 16, v77
    v_and_b32 v187, 4294901760, v77
    v_lshlrev_b32 v188, 16, v78
    v_and_b32 v189, 4294901760, v78
    v_lshlrev_b32 v190, 16, v79
    v_mfma_f32_32x32x16_bf16 v[32:47], v[132:135], v[72:75], v[32:47]
    s_add_u32 m0, s8, 24576
    s_nop 0
    buffer_load_dwordx4 v2, s[40:43], s10 offen offset:1024 lds
    v_and_b32 v191, 4294901760, v79
    v_fma_f32 v184, v184, v176, v168
    v_fma_f32 v185, v185, v177, v169
    v_fma_f32 v186, v186, v178, v170
    v_fma_f32 v187, v187, v179, v171
    v_fma_f32 v188, v188, v180, v172
    v_fma_f32 v189, v189, v181, v173
    v_mfma_f32_32x32x16_bf16 v[48:63], v[72:75], v[136:139], v[48:63]
    v_fma_f32 v190, v190, v182, v174
    v_fma_f32 v191, v191, v183, v175
    v_cvt_pk_bf16_f32 v76, v184, v185
    v_cvt_pk_bf16_f32 v77, v186, v187
    v_cvt_pk_bf16_f32 v78, v188, v189
    v_cvt_pk_bf16_f32 v79, v190, v191
    s_waitcnt vmcnt(5)
    s_barrier
    ds_read_b128 v[128:131], v3 offset:12288
    ds_read_b128 v[132:135], v3 offset:13312
    ds_read_b128 v[136:139], v3 offset:14336
    ds_read_b128 v[168:171], v5 offset:320
    ds_read_b128 v[172:175], v5 offset:336
    ds_read_b128 v[176:179], v5 offset:2368
    ds_read_b128 v[180:183], v5 offset:2384
    s_waitcnt lgkmcnt(7)
    v_mfma_f32_32x32x16_bf16 v[16:31], v[140:143], v[76:79], v[16:31]
    s_add_u32 m0, s8, 24576
    s_nop 0
    buffer_load_dwordx4 v2, s[40:43], s10 offen offset:2048 lds
    v_lshlrev_b32 v184, 16, v80
    v_and_b32 v185, 4294901760, v80
    v_lshlrev_b32 v186, 16, v81
    v_and_b32 v187, 4294901760, v81
    v_lshlrev_b32 v188, 16, v82
    v_and_b32 v189, 4294901760, v82
    v_lshlrev_b32 v190, 16, v83
    v_mfma_f32_32x32x16_bf16 v[32:47], v[144:147], v[76:79], v[32:47]
    s_add_u32 s11, s9, 8192
    buffer_load_dwordx4 v[96:99], v2, s[40:43], s11 offen offset:0
    v_and_b32 v191, 4294901760, v83
    v_fma_f32 v184, v184, v160, v152
    v_fma_f32 v185, v185, v161, v153
    v_fma_f32 v186, v186, v162, v154
    v_fma_f32 v187, v187, v163, v155
    v_fma_f32 v188, v188, v164, v156
    v_fma_f32 v189, v189, v165, v157
    v_mfma_f32_32x32x16_bf16 v[48:63], v[76:79], v[148:151], v[48:63]
    v_fma_f32 v190, v190, v166, v158
    v_fma_f32 v191, v191, v167, v159
    v_cvt_pk_bf16_f32 v80, v184, v185
    v_cvt_pk_bf16_f32 v81, v186, v187
    v_cvt_pk_bf16_f32 v82, v188, v189
    v_cvt_pk_bf16_f32 v83, v190, v191
    s_waitcnt vmcnt(6)
    ds_read_b128 v[140:143], v3 offset:15360
    ds_read_b128 v[144:147], v3 offset:16384
    ds_read_b128 v[148:151], v3 offset:17408
    ds_read_b128 v[152:155], v5 offset:384
    ds_read_b128 v[156:159], v5 offset:400
    ds_read_b128 v[160:163], v5 offset:2432
    ds_read_b128 v[164:167], v5 offset:2448
    s_waitcnt lgkmcnt(7)
    v_mfma_f32_32x32x16_bf16 v[16:31], v[128:131], v[80:83], v[16:31]
    buffer_load_dwordx4 v[100:103], v2, s[40:43], s11 offen offset:1024
    v_lshlrev_b32 v184, 16, v84
    v_and_b32 v185, 4294901760, v84
    v_lshlrev_b32 v186, 16, v85
    v_and_b32 v187, 4294901760, v85
    v_lshlrev_b32 v188, 16, v86
    v_and_b32 v189, 4294901760, v86
    v_lshlrev_b32 v190, 16, v87
    v_mfma_f32_32x32x16_bf16 v[32:47], v[132:135], v[80:83], v[32:47]
    buffer_load_dwordx4 v[104:107], v2, s[40:43], s11 offen offset:2048
    v_and_b32 v191, 4294901760, v87
    v_fma_f32 v184, v184, v176, v168
    v_fma_f32 v185, v185, v177, v169
    v_fma_f32 v186, v186, v178, v170
    v_fma_f32 v187, v187, v179, v171
    v_fma_f32 v188, v188, v180, v172
    v_fma_f32 v189, v189, v181, v173
    v_mfma_f32_32x32x16_bf16 v[48:63], v[80:83], v[136:139], v[48:63]
    v_fma_f32 v190, v190, v182, v174
    v_fma_f32 v191, v191, v183, v175
    v_cvt_pk_bf16_f32 v84, v184, v185
    v_cvt_pk_bf16_f32 v85, v186, v187
    v_cvt_pk_bf16_f32 v86, v188, v189
    v_cvt_pk_bf16_f32 v87, v190, v191
    s_waitcnt vmcnt(7)
    ds_read_b128 v[128:131], v3 offset:18432
    ds_read_b128 v[132:135], v3 offset:19456
    ds_read_b128 v[136:139], v3 offset:20480
    ds_read_b128 v[168:171], v5 offset:448
    ds_read_b128 v[172:175], v5 offset:464
    ds_read_b128 v[176:179], v5 offset:2496
    ds_read_b128 v[180:183], v5 offset:2512
    s_waitcnt lgkmcnt(7)
    v_mfma_f32_32x32x16_bf16 v[16:31], v[140:143], v[84:87], v[16:31]
    buffer_load_dwordx4 v[108:111], v2, s[40:43], s11 offen offset:3072
    v_lshlrev_b32 v184, 16, v88
    v_and_b32 v185, 4294901760, v88
    v_lshlrev_b32 v186, 16, v89
    v_and_b32 v187, 4294901760, v89
    v_lshlrev_b32 v188, 16, v90
    v_and_b32 v189, 4294901760, v90
    v_lshlrev_b32 v190, 16, v91
    v_mfma_f32_32x32x16_bf16 v[32:47], v[144:147], v[84:87], v[32:47]
    s_add_u32 s10, s7, 36864
    s_add_u32 m0, s8, 36864
    s_nop 0
    buffer_load_dwordx4 v2, s[40:43], s10 offen offset:0 lds
    v_and_b32 v191, 4294901760, v91
    v_fma_f32 v184, v184, v160, v152
    v_fma_f32 v185, v185, v161, v153
    v_fma_f32 v186, v186, v162, v154
    v_fma_f32 v187, v187, v163, v155
    v_fma_f32 v188, v188, v164, v156
    v_fma_f32 v189, v189, v165, v157
    v_mfma_f32_32x32x16_bf16 v[48:63], v[84:87], v[148:151], v[48:63]
    v_fma_f32 v190, v190, v166, v158
    v_fma_f32 v191, v191, v167, v159
    v_cvt_pk_bf16_f32 v88, v184, v185
    v_cvt_pk_bf16_f32 v89, v186, v187
    v_cvt_pk_bf16_f32 v90, v188, v189
    v_cvt_pk_bf16_f32 v91, v190, v191
    s_waitcnt vmcnt(8)
    ds_read_b128 v[140:143], v3 offset:21504
    ds_read_b128 v[144:147], v3 offset:22528
    ds_read_b128 v[148:151], v3 offset:23552
    ds_read_b128 v[152:155], v5 offset:512
    ds_read_b128 v[156:159], v5 offset:528
    ds_read_b128 v[160:163], v5 offset:2560
    ds_read_b128 v[164:167], v5 offset:2576
    s_waitcnt lgkmcnt(7)
    v_mfma_f32_32x32x16_bf16 v[16:31], v[128:131], v[88:91], v[16:31]
    s_add_u32 m0, s8, 36864
    s_nop 0
    buffer_load_dwordx4 v2, s[40:43], s10 offen offset:1024 lds
    v_lshlrev_b32 v184, 16, v92
    v_and_b32 v185, 4294901760, v92
    v_lshlrev_b32 v186, 16, v93
    v_and_b32 v187, 4294901760, v93
    v_lshlrev_b32 v188, 16, v94
    v_and_b32 v189, 4294901760, v94
    v_lshlrev_b32 v190, 16, v95
    v_mfma_f32_32x32x16_bf16 v[32:47], v[132:135], v[88:91], v[32:47]
    s_add_u32 m0, s8, 36864
    s_nop 0
    buffer_load_dwordx4 v2, s[40:43], s10 offen offset:2048 lds
    v_and_b32 v191, 4294901760, v95
    v_fma_f32 v184, v184, v176, v168
    v_fma_f32 v185, v185, v177, v169
    v_fma_f32 v186, v186, v178, v170
    v_fma_f32 v187, v187, v179, v171
    v_fma_f32 v188, v188, v180, v172
    v_fma_f32 v189, v189, v181, v173
    v_mfma_f32_32x32x16_bf16 v[48:63], v[88:91], v[136:139], v[48:63]
    v_fma_f32 v190, v190, v182, v174
    v_fma_f32 v191, v191, v183, v175
    v_cvt_pk_bf16_f32 v92, v184, v185
    v_cvt_pk_bf16_f32 v93, v186, v187
    v_cvt_pk_bf16_f32 v94, v188, v189
    v_cvt_pk_bf16_f32 v95, v190, v191
    s_waitcnt vmcnt(6)
    s_barrier
    ds_read_b128 v[128:131], v3 offset:24576
    ds_read_b128 v[132:135], v3 offset:25600
    ds_read_b128 v[136:139], v3 offset:26624
    ds_read_b128 v[168:171], v5 offset:576
    ds_read_b128 v[172:175], v5 offset:592
    ds_read_b128 v[176:179], v5 offset:2624
    ds_read_b128 v[180:183], v5 offset:2640
    s_waitcnt lgkmcnt(7)
    v_mfma_f32_32x32x16_bf16 v[16:31], v[140:143], v[92:95], v[16:31]
    s_add_u32 s11, s9, 12288
    buffer_load_dwordx4 v[112:115], v2, s[40:43], s11 offen offset:0
    v_lshlrev_b32 v184, 16, v96
    v_and_b32 v185, 4294901760, v96
    v_lshlrev_b32 v186, 16, v97
    v_and_b32 v187, 4294901760, v97
    v_lshlrev_b32 v188, 16, v98
    v_and_b32 v189, 4294901760, v98
    v_lshlrev_b32 v190, 16, v99
    v_mfma_f32_32x32x16_bf16 v[32:47], v[144:147], v[92:95], v[32:47]
    buffer_load_dwordx4 v[116:119], v2, s[40:43], s11 offen offset:1024
    v_and_b32 v191, 4294901760, v99
    v_fma_f32 v184, v184, v160, v152
    v_fma_f32 v185, v185, v161, v153
    v_fma_f32 v186, v186, v162, v154
    v_fma_f32 v187, v187, v163, v155
    v_fma_f32 v188, v188, v164, v156
    v_fma_f32 v189, v189, v165, v157
    v_mfma_f32_32x32x16_bf16 v[48:63], v[92:95], v[148:151], v[48:63]
    v_fma_f32 v190, v190, v166, v158
    v_fma_f32 v191, v191, v167, v159
    v_cvt_pk_bf16_f32 v96, v184, v185
    v_cvt_pk_bf16_f32 v97, v186, v187
    v_cvt_pk_bf16_f32 v98, v188, v189
    v_cvt_pk_bf16_f32 v99, v190, v191
    s_waitcnt vmcnt(7)
    ds_read_b128 v[140:143], v3 offset:27648
    ds_read_b128 v[144:147], v3 offset:28672
    ds_read_b128 v[148:151], v3 offset:29696
    ds_read_b128 v[152:155], v5 offset:640
    ds_read_b128 v[156:159], v5 offset:656
    ds_read_b128 v[160:163], v5 offset:2688
    ds_read_b128 v[164:167], v5 offset:2704
    s_waitcnt lgkmcnt(7)
    v_mfma_f32_32x32x16_bf16 v[16:31], v[128:131], v[96:99], v[16:31]
    buffer_load_dwordx4 v[120:123], v2, s[40:43], s11 offen offset:2048
    v_lshlrev_b32 v184, 16, v100
    v_and_b32 v185, 4294901760, v100
    v_lshlrev_b32 v186, 16, v101
    v_and_b32 v187, 4294901760, v101
    v_lshlrev_b32 v188, 16, v102
    v_and_b32 v189, 4294901760, v102
    v_lshlrev_b32 v190, 16, v103
    v_mfma_f32_32x32x16_bf16 v[32:47], v[132:135], v[96:99], v[32:47]
    buffer_load_dwordx4 v[124:127], v2, s[40:43], s11 offen offset:3072
    v_and_b32 v191, 4294901760, v103
    v_fma_f32 v184, v184, v176, v168
    v_fma_f32 v185, v185, v177, v169
    v_fma_f32 v186, v186, v178, v170
    v_fma_f32 v187, v187, v179, v171
    v_fma_f32 v188, v188, v180, v172
    v_fma_f32 v189, v189, v181, v173
    v_mfma_f32_32x32x16_bf16 v[48:63], v[96:99], v[136:139], v[48:63]
    v_fma_f32 v190, v190, v182, v174
    v_fma_f32 v191, v191, v183, v175
    v_cvt_pk_bf16_f32 v100, v184, v185
    v_cvt_pk_bf16_f32 v101, v186, v187
    v_cvt_pk_bf16_f32 v102, v188, v189
    v_cvt_pk_bf16_f32 v103, v190, v191
    s_waitcnt vmcnt(8)
    ds_read_b128 v[128:131], v3 offset:30720
    ds_read_b128 v[132:135], v3 offset:31744
    ds_read_b128 v[136:139], v3 offset:32768
    ds_read_b128 v[168:171], v5 offset:704
    ds_read_b128 v[172:175], v5 offset:720
    ds_read_b128 v[176:179], v5 offset:2752
    ds_read_b128 v[180:183], v5 offset:2768
    s_waitcnt lgkmcnt(7)
    v_mfma_f32_32x32x16_bf16 v[16:31], v[140:143], v[100:103], v[16:31]
    s_getpc_b64 s[44:45]
L_pc_k1_qkv_kernel:
    s_lshr_b32 s46, s2, 3
    s_mul_i32 s46, s46, 8
    s_add_u32 s46, s46, s3
    s_lshl_b32 s46, s46, 13
    v_lshlrev_b32 v7, 7, v1
    v_add_u32 v7, s46, v7
    v_min_u32 v7, k3_wo_kernel-k2_attn_kernel-4, v7
    v_add_u32 v7, k2_attn_kernel-L_pc_k1_qkv_kernel, v7
    global_load_dword v196, v7, s[44:45]
    v_lshlrev_b32 v184, 16, v104
    v_and_b32 v185, 4294901760, v104
    v_lshlrev_b32 v186, 16, v105
    v_and_b32 v187, 4294901760, v105
    v_lshlrev_b32 v188, 16, v106
    v_and_b32 v189, 4294901760, v106
    v_lshlrev_b32 v190, 16, v107
    v_mfma_f32_32x32x16_bf16 v[32:47], v[144:147], v[100:103], v[32:47]
    v_and_b32 v191, 4294901760, v107
    v_fma_f32 v184, v184, v160, v152
    v_fma_f32 v185, v185, v161, v153
    v_fma_f32 v186, v186, v162, v154
    v_fma_f32 v187, v187, v163, v155
    v_fma_f32 v188, v188, v164, v156
    v_fma_f32 v189, v189, v165, v157
    v_mfma_f32_32x32x16_bf16 v[48:63], v[100:103], v[148:151], v[48:63]
    v_fma_f32 v190, v190, v166, v158
    v_fma_f32 v191, v191, v167, v159
    v_cvt_pk_bf16_f32 v104, v184, v185
    v_cvt_pk_bf16_f32 v105, v186, v187
    v_cvt_pk_bf16_f32 v106, v188, v189
    v_cvt_pk_bf16_f32 v107, v190, v191
    s_waitcnt vmcnt(8)
    ds_read_b128 v[140:143], v3 offset:33792
    ds_read_b128 v[144:147], v3 offset:34816
    ds_read_b128 v[148:151], v3 offset:35840
    ds_read_b128 v[152:155], v5 offset:768
    ds_read_b128 v[156:159], v5 offset:784
    ds_read_b128 v[160:163], v5 offset:2816
    ds_read_b128 v[164:167], v5 offset:2832
    s_waitcnt lgkmcnt(7)
    v_mfma_f32_32x32x16_bf16 v[16:31], v[128:131], v[104:107], v[16:31]
    v_lshlrev_b32 v184, 16, v108
    v_and_b32 v185, 4294901760, v108
    v_lshlrev_b32 v186, 16, v109
    v_and_b32 v187, 4294901760, v109
    v_lshlrev_b32 v188, 16, v110
    v_and_b32 v189, 4294901760, v110
    v_lshlrev_b32 v190, 16, v111
    v_mfma_f32_32x32x16_bf16 v[32:47], v[132:135], v[104:107], v[32:47]
    v_and_b32 v191, 4294901760, v111
    v_fma_f32 v184, v184, v176, v168
    v_fma_f32 v185, v185, v177, v169
    v_fma_f32 v186, v186, v178, v170
    v_fma_f32 v187, v187, v179, v171
    v_fma_f32 v188, v188, v180, v172
    v_fma_f32 v189, v189, v181, v173
    v_mfma_f32_32x32x16_bf16 v[48:63], v[104:107], v[136:139], v[48:63]
    v_fma_f32 v190, v190, v182, v174
    v_fma_f32 v191, v191, v183, v175
    v_cvt_pk_bf16_f32 v108, v184, v185
    v_cvt_pk_bf16_f32 v109, v186, v187
    v_cvt_pk_bf16_f32 v110, v188, v189
    v_cvt_pk_bf16_f32 v111, v190, v191
    s_waitcnt vmcnt(4)
    s_barrier
    ds_read_b128 v[128:131], v3 offset:36864
    ds_read_b128 v[132:135], v3 offset:37888
    ds_read_b128 v[136:139], v3 offset:38912
    ds_read_b128 v[168:171], v5 offset:832
    ds_read_b128 v[172:175], v5 offset:848
    ds_read_b128 v[176:179], v5 offset:2880
    ds_read_b128 v[180:183], v5 offset:2896
    s_waitcnt lgkmcnt(7)
    v_mfma_f32_32x32x16_bf16 v[16:31], v[140:143], v[108:111], v[16:31]
    v_lshlrev_b32 v184, 16, v112
    v_and_b32 v185, 4294901760, v112
    v_lshlrev_b32 v186, 16, v113
    v_and_b32 v187, 4294901760, v113
    v_lshlrev_b32 v188, 16, v114
    v_and_b32 v189, 4294901760, v114
    v_lshlrev_b32 v190, 16, v115
    v_mfma_f32_32x32x16_bf16 v[32:47], v[144:147], v[108:111], v[32:47]
    v_and_b32 v191, 4294901760, v115
    v_fma_f32 v184, v184, v160, v152
    v_fma_f32 v185, v185, v161, v153
    v_fma_f32 v186, v186, v162, v154
    v_fma_f32 v187, v187, v163, v155
    v_fma_f32 v188, v188, v164, v156
    v_fma_f32 v189, v189, v165, v157
    v_mfma_f32_32x32x16_bf16 v[48:63], v[108:111], v[148:151], v[48:63]
    v_fma_f32 v190, v190, v166, v158
    v_fma_f32 v191, v191, v167, v159
    v_cvt_pk_bf16_f32 v112, v184, v185
    v_cvt_pk_bf16_f32 v113, v186, v187
    v_cvt_pk_bf16_f32 v114, v188, v189
    v_cvt_pk_bf16_f32 v115, v190, v191
    s_waitcnt vmcnt(3)
    ds_read_b128 v[140:143], v3 offset:39936
    ds_read_b128 v[144:147], v3 offset:40960
    ds_read_b128 v[148:151], v3 offset:41984
    ds_read_b128 v[152:155], v5 offset:896
    ds_read_b128 v[156:159], v5 offset:912
    ds_read_b128 v[160:163], v5 offset:2944
    ds_read_b128 v[164:167], v5 offset:2960
    s_waitcnt lgkmcnt(7)
    v_mfma_f32_32x32x16_bf16 v[16:31], v[128:131], v[112:115], v[16:31]
    v_lshlrev_b32 v184, 16, v116
    v_and_b32 v185, 4294901760, v116
    v_lshlrev_b32 v186, 16, v117
    v_and_b32 v187, 4294901760, v117
    v_lshlrev_b32 v188, 16, v118
    v_and_b32 v189, 4294901760, v118
    v_lshlrev_b32 v190, 16, v119
    v_mfma_f32_32x32x16_bf16 v[32:47], v[132:135], v[112:115], v[32:47]
    v_and_b32 v191, 4294901760, v119
    v_fma_f32 v184, v184, v176, v168
    v_fma_f32 v185, v185, v177, v169
    v_fma_f32 v186, v186, v178, v170
    v_fma_f32 v187, v187, v179, v171
    v_fma_f32 v188, v188, v180, v172
    v_fma_f32 v189, v189, v181, v173
    v_mfma_f32_32x32x16_bf16 v[48:63], v[112:115], v[136:139], v[48:63]
    v_fma_f32 v190, v190, v182, v174
    v_fma_f32 v191, v191, v183, v175
    v_cvt_pk_bf16_f32 v116, v184, v185
    v_cvt_pk_bf16_f32 v117, v186, v187
    v_cvt_pk_bf16_f32 v118, v188, v189
    v_cvt_pk_bf16_f32 v119, v190, v191
    s_waitcnt vmcnt(2)
    ds_read_b128 v[128:131], v3 offset:43008
    ds_read_b128 v[132:135], v3 offset:44032
    ds_read_b128 v[136:139], v3 offset:45056
    ds_read_b128 v[168:171], v5 offset:960
    ds_read_b128 v[172:175], v5 offset:976
    ds_read_b128 v[176:179], v5 offset:3008
    ds_read_b128 v[180:183], v5 offset:3024
    s_waitcnt lgkmcnt(7)
    v_mfma_f32_32x32x16_bf16 v[16:31], v[140:143], v[116:119], v[16:31]
    v_lshlrev_b32 v184, 16, v120
    v_and_b32 v185, 4294901760, v120
    v_lshlrev_b32 v186, 16, v121
    v_and_b32 v187, 4294901760, v121
    v_lshlrev_b32 v188, 16, v122
    v_and_b32 v189, 4294901760, v122
    v_lshlrev_b32 v190, 16, v123
    v_mfma_f32_32x32x16_bf16 v[32:47], v[144:147], v[116:119], v[32:47]
    v_and_b32 v191, 4294901760, v123
    v_fma_f32 v184, v184, v160, v152
    v_fma_f32 v185, v185, v161, v153
    v_fma_f32 v186, v186, v162, v154
    v_fma_f32 v187, v187, v163, v155
    v_fma_f32 v188, v188, v164, v156
    v_fma_f32 v189, v189, v165, v157
    v_mfma_f32_32x32x16_bf16 v[48:63], v[116:119], v[148:151], v[48:63]
    v_fma_f32 v190, v190, v166, v158
    v_fma_f32 v191, v191, v167, v159
    v_cvt_pk_bf16_f32 v120, v184, v185
    v_cvt_pk_bf16_f32 v121, v186, v187
    v_cvt_pk_bf16_f32 v122, v188, v189
    v_cvt_pk_bf16_f32 v123, v190, v191
    s_waitcnt vmcnt(1)
    ds_read_b128 v[140:143], v3 offset:46080
    ds_read_b128 v[144:147], v3 offset:47104
    ds_read_b128 v[148:151], v3 offset:48128
    s_waitcnt lgkmcnt(3)
    v_mfma_f32_32x32x16_bf16 v[16:31], v[128:131], v[120:123], v[16:31]
    v_lshlrev_b32 v184, 16, v124
    v_and_b32 v185, 4294901760, v124
    v_lshlrev_b32 v186, 16, v125
    v_and_b32 v187, 4294901760, v125
    v_lshlrev_b32 v188, 16, v126
    v_and_b32 v189, 4294901760, v126
    v_lshlrev_b32 v190, 16, v127
    v_mfma_f32_32x32x16_bf16 v[32:47], v[132:135], v[120:123], v[32:47]
    v_and_b32 v191, 4294901760, v127
    v_fma_f32 v184, v184, v176, v168
    v_fma_f32 v185, v185, v177, v169
    v_fma_f32 v186, v186, v178, v170
    v_fma_f32 v187, v187, v179, v171
    v_fma_f32 v188, v188, v180, v172
    v_fma_f32 v189, v189, v181, v173
    v_mfma_f32_32x32x16_bf16 v[48:63], v[120:123], v[136:139], v[48:63]
    v_fma_f32 v190, v190, v182, v174
    v_fma_f32 v191, v191, v183, v175
    v_cvt_pk_bf16_f32 v124, v184, v185
    v_cvt_pk_bf16_f32 v125, v186, v187
    v_cvt_pk_bf16_f32 v126, v188, v189
    v_cvt_pk_bf16_f32 v127, v190, v191
    s_waitcnt lgkmcnt(0)
    s_nop 0
    v_mfma_f32_32x32x16_bf16 v[16:31], v[140:143], v[124:127], v[16:31]
    v_mfma_f32_32x32x16_bf16 v[32:47], v[144:147], v[124:127], v[32:47]
    v_mfma_f32_32x32x16_bf16 v[48:63], v[124:127], v[148:151], v[48:63]
    s_mul_i32 s10, s3, 6144
    s_add_u32 s10, s10, 102400
    v_add_u32 v6, s10, v2
    s_xor_b32 s11, s3, 4
    s_mul_i32 s11, s11, 6144
    s_add_u32 s11, s11, 102400
    v_add_u32 v7, s11, v2
    s_lshl_b32 s11, s5, 17
    s_lshl_b32 s12, s6, 10
    s_add_u32 s11, s11, s12
    s_mul_i32 s12, s63, -4194304
    s_add_u32 s12, s12, s11
    s_add_u32 s12, s12, 7864320
    s_add_u32 s13, s12, 65536
    s_lshl_b32 s14, s63, 9
    s_add_u32 s14, s14, s11
    s_add_u32 s14, s14, 5767168
    v_bfe_u32 v4, v1, 4, 1
    v_lshlrev_b32 v4, 16, v4
    v_lshrrev_b32 v5, 5, v1
    v_lshl_add_u32 v4, v5, 8, v4
    v_and_b32 v5, 15, v1
    v_lshl_add_u32 v4, v5, 4, v4
    s_nop 2
    s_cmp_eq_u32 s63, 0
    s_cbranch_scc0 L_k1_x1
    ds_write_b128 v6, v[32:35] offset:0
    ds_write_b128 v6, v[36:39] offset:1024
    ds_write_b128 v6, v[40:43] offset:2048
    ds_write_b128 v6, v[44:47] offset:3072
    ds_write_b128 v6, v[56:59] offset:4096
    ds_write_b128 v6, v[60:63] offset:5120
    s_mov_b32 s15, 1052289595
    v_mov_b32 v64, v16
    v_mov_b32 v65, v17
    v_mov_b32 v66, v18
    v_mov_b32 v67, v19
    v_mov_b32 v68, v20
    v_mov_b32 v69, v21
    v_mov_b32 v70, v22
    v_mov_b32 v71, v23
    v_mov_b32 v72, v24
    v_mov_b32 v73, v25
    v_mov_b32 v74, v26
    v_mov_b32 v75, v27
    v_mov_b32 v76, v28
    v_mov_b32 v77, v29
    v_mov_b32 v78, v30
    v_mov_b32 v79, v31
    v_mov_b32 v80, v48
    v_mov_b32 v81, v49
    v_mov_b32 v82, v50
    v_mov_b32 v83, v51
    v_mov_b32 v84, v52
    v_mov_b32 v85, v53
    v_mov_b32 v86, v54
    v_mov_b32 v87, v55
    s_branch L_k1_x2
    s_nop 1
L_k1_x1:
    ds_write_b128 v6, v[16:19] offset:0
    ds_write_b128 v6, v[20:23] offset:1024
    ds_write_b128 v6, v[24:27] offset:2048
    ds_write_b128 v6, v[28:31] offset:3072
    ds_write_b128 v6, v[48:51] offset:4096
    ds_write_b128 v6, v[52:55] offset:5120
    s_mov_b32 s15, 1065353216
    v_mov_b32 v64, v32
    v_mov_b32 v65, v33
    v_mov_b32 v66, v34
    v_mov_b32 v67, v35
    v_mov_b32 v68, v36
    v_mov_b32 v69, v37
    v_mov_b32 v70, v38
    v_mov_b32 v71, v39
    v_mov_b32 v72, v40
    v_mov_b32 v73, v41
    v_mov_b32 v74, v42
    v_mov_b32 v75, v43
    v_mov_b32 v76, v44
    v_mov_b32 v77, v45
    v_mov_b32 v78, v46
    v_mov_b32 v79, v47
    v_mov_b32 v80, v56
    v_mov_b32 v81, v57
    v_mov_b32 v82, v58
    v_mov_b32 v83, v59
    v_mov_b32 v84, v60
    v_mov_b32 v85, v61
    v_mov_b32 v86, v62
    v_mov_b32 v87, v63
    s_nop 2
L_k1_x2:
    s_waitcnt lgkmcnt(0)
    s_barrier
    ds_read_b128 v[16:19], v7 offset:0
    ds_read_b128 v[20:23], v7 offset:1024
    ds_read_b128 v[24:27], v7 offset:2048
    ds_read_b128 v[28:31], v7 offset:3072
    ds_read_b128 v[32:35], v7 offset:4096
    ds_read_b128 v[36:39], v7 offset:5120
    s_waitcnt lgkmcnt(4)
    v_add_f32 v64, v64, v16
    v_add_f32 v65, v65, v17
    v_add_f32 v66, v66, v18
    v_add_f32 v67, v67, v19
    v_add_f32 v68, v68, v20
    v_add_f32 v69, v69, v21
    v_add_f32 v70, v70, v22
    v_add_f32 v71, v71, v23
    v_mul_f32 v64, s15, v64
    v_mul_f32 v65, s15, v65
    v_mul_f32 v66, s15, v66
    v_mul_f32 v67, s15, v67
    v_mul_f32 v68, s15, v68
    v_mul_f32 v69, s15, v69
    v_mul_f32 v70, s15, v70
    v_mul_f32 v71, s15, v71
    v_cvt_pk_bf16_f32 v128, v64, v65
    v_cvt_pk_bf16_f32 v129, v66, v67
    v_cvt_pk_bf16_f32 v130, v68, v69
    v_cvt_pk_bf16_f32 v131, v70, v71
    buffer_store_dwordx4 v[128:131], v2, s[40:43], s12 offen sc1
    s_waitcnt lgkmcnt(2)
    v_add_f32 v72, v72, v24
    v_add_f32 v73, v73, v25
    v_add_f32 v74, v74, v26
    v_add_f32 v75, v75, v27
    v_add_f32 v76, v76, v28
    v_add_f32 v77, v77, v29
    v_add_f32 v78, v78, v30
    v_add_f32 v79, v79, v31
    v_mul_f32 v72, s15, v72
    v_mul_f32 v73, s15, v73
    v_mul_f32 v74, s15, v74
    v_mul_f32 v75, s15, v75
    v_mul_f32 v76, s15, v76
    v_mul_f32 v77, s15, v77
    v_mul_f32 v78, s15, v78
    v_mul_f32 v79, s15, v79
    v_cvt_pk_bf16_f32 v132, v72, v73
    v_cvt_pk_bf16_f32 v133, v74, v75
    v_cvt_pk_bf16_f32 v134, v76, v77
    v_cvt_pk_bf16_f32 v135, v78, v79
    buffer_store_dwordx4 v[132:135], v2, s[40:43], s13 offen sc1
    s_waitcnt lgkmcnt(0)
    v_add_f32 v80, v80, v32
    v_add_f32 v81, v81, v33
    v_add_f32 v82, v82, v34
    v_add_f32 v83, v83, v35
    v_add_f32 v84, v84, v36
    v_add_f32 v85, v85, v37
    v_add_f32 v86, v86, v38
    v_add_f32 v87, v87, v39
    v_cvt_pk_bf16_f32 v136, v80, v81
    v_cvt_pk_bf16_f32 v137, v82, v83
    v_cvt_pk_bf16_f32 v138, v84, v85
    v_cvt_pk_bf16_f32 v139, v86, v87
    buffer_store_dwordx4 v[136:139], v4, s[40:43], s14 offen sc1
    v_dot2_f32_bf16 v8, v128, v128, 0
    v_dot2_f32_bf16 v10, v129, v129, 0
    v_dot2_f32_bf16 v9, v132, v132, 0
    v_dot2_f32_bf16 v11, v133, v133, 0
    v_dot2_f32_bf16 v8, v130, v130, v8
    v_dot2_f32_bf16 v10, v131, v131, v10
    v_dot2_f32_bf16 v9, v134, v134, v9
    v_dot2_f32_bf16 v11, v135, v135, v11
    s_nop 0
    v_add_f32 v8, v8, v10
    s_nop 0
    v_add_f32 v9, v9, v11
    s_nop 1
    v_permlane32_swap_b32 v8, v9
    v_add_f32 v8, v8, v9
    v_mov_b32 v9, v8
    s_nop 1
    v_max_f32 v9, v9, v9 row_shr:1 row_mask:0xf bank_mask:0xf
    s_nop 1
    v_max_f32 v9, v9, v9 row_shr:2 row_mask:0xf bank_mask:0xf
    s_nop 1
    v_max_f32 v9, v9, v9 row_shr:4 row_mask:0xf bank_mask:0xf
    s_nop 1
    v_max_f32 v9, v9, v9 row_shr:8 row_mask:0xf bank_mask:0xf
    s_nop 1
    v_max_f32 v9, v9, v9 row_bcast:15 row_mask:0xa bank_mask:0xf
    s_lshl_b32 s10, s63, 18
    s_lshl_b32 s11, s5, 14
    s_add_u32 s10, s10, s11
    s_lshl_b32 s11, s6, 7
    s_add_u32 s10, s10, s11
    s_add_u32 s10, s10, 10223616
    v_lshrrev_b32 v10, 5, v1
    v_lshlrev_b32 v11, 13, v10
    v_and_b32 v12, 31, v1
    v_lshl_add_u32 v11, v12, 2, v11
    buffer_store_dword v8, v11, s[40:43], s10 offen
    s_lshl_b32 s10, s63, 13
    s_lshl_b32 s11, s5, 9
    s_add_u32 s10, s10, s11
    s_lshl_b32 s11, s6, 2
    s_add_u32 s10, s10, s11
    s_add_u32 s10, s10, 10747904
    v_lshlrev_b32 v11, 8, v10
    s_mov_b32 exec_lo, 2147483648
    s_mov_b32 exec_hi, 2147483648
    buffer_store_dword v9, v11, s[40:43], s10 offen
    s_mov_b64 exec, -1
    s_cmp_ge_u32 s2, 4
    s_cbranch_scc1 L_k1_nomod
    v_lshlrev_b32 v3, 2, v0
    v_add_f32 v16, v192, v193
    v_add_f32 v18, v194, v195
    v_add_f32 v16, v16, v18
    v_cvt_pk_bf16_f32 v17, v16, v16
    v_and_b32 v18, 4294901760, v17
    v_add_f32 v19, 1.0, v18
    v_cvt_pk_bf16_f32 v19, v19, v19
    v_and_b32 v19, 4294901760, v19
    s_cmp_eq_u32 s2, 1
    s_cbranch_scc1 L_k1_sb
    s_mov_b32 s13, 4096
    s_cmp_eq_u32 s2, 2
    s_cselect_b64 vcc, -1, 0
    v_cndmask_b32 v18, v18, v19, vcc
    s_cselect_b32 s13, 2048, s13
    s_cmp_eq_u32 s2, 0
    s_cselect_b32 s13, 0, s13
    s_add_u32 s13, s13, 10092544
    buffer_store_dword v18, v3, s[40:43], s13 offen
    s_branch L_k1_nomod
L_k1_sb:
    s_mov_b32 s13, 10098688
    v_lshlrev_b32 v3, 1, v0
    buffer_store_short v17, v3, s[40:43], s13 offen
    s_nop 1
L_k1_nomod:
L_end_k1_qkv_kernel:
    s_endpgm

.globl k2_attn_kernel
.p2align 8
.type k2_attn_kernel,@function
k2_attn_kernel:
    s_cmp_ge_u32 s2, 256
    s_cbranch_scc1 L_end_k2_attn_kernel
    s_load_dwordx16 s[16:31], s[0:1], 0
    s_load_dwordx8 s[32:39], s[0:1], 64
    v_and_b32 v1, 63, v0
    v_lshrrev_b32 v2, 6, v0
    s_nop 0
    v_readfirstlane_b32 s3, v2
    s_bfe_u32 s5, s2, 131073
    s_lshl_b32 s5, s5, 1
    s_bfe_u32 s4, s2, 65539
    s_add_u32 s5, s5, s4
    s_and_b32 s4, s2, 1
    s_lshl_b32 s4, s4, 4
    s_lshr_b32 s62, s2, 4
    s_add_u32 s4, s4, s62
    s_lshl_b32 s6, s5, 3
    s_add_u32 s6, s6, s3
    v_lshlrev_b32 v2, 4, v1
    s_lshl_b32 s9, s4, 16
    s_lshl_b32 s10, s6, 10
    s_add_u32 s10, s10, s9
    s_add_u32 s10, s10, 7864320
    s_lshl_b32 s8, s3, 11
    v_lshrrev_b32 v3, 5, v1
    v_bfe_u32 v4, v1, 4, 1
    v_bfe_u32 v5, v1, 2, 2
    v_and_b32 v6, 1, v1
    v_bfe_u32 v7, v1, 1, 1
    v_lshl_add_u32 v6, v6, 1, v7
    v_lshlrev_b32 v13, 8, v3
    v_and_b32 v14, 15, v1
    v_lshl_add_u32 v13, v14, 4, v13
    v_and_b32 v12, 31, v1
    v_lshlrev_b32 v12, 2, v12
    v_lshlrev_b32 v14, 5, v3
    v_lshlrev_b32 v15, 4, v3
    s_and_b32 s12, s3, 3
    s_mul_i32 s13, s2, 3
    s_add_u32 s13, s13, s12
    s_lshr_b32 s15, s2, 1
    s_add_u32 s15, s15, 768
    s_cmp_eq_u32 s3, 3
    s_cselect_b32 s57, s15, s13
    s_and_b32 s15, s2, 1
    s_lshr_b32 s13, s3, 2
    s_cmp_eq_u32 s3, 3
    s_cselect_b32 s64, s15, s13
    s_cmp_eq_u32 s3, 7
    s_cselect_b32 s57, s2, s57
    s_mul_i32 s66, s57, 2341
    s_lshr_b32 s66, s66, 16
    s_min_u32 s66, s66, 31
    s_mul_i32 s65, s66, 28
    s_sub_u32 s65, s57, s65
    s_lshl_b32 s67, s66, 6
    s_add_u32 s67, s67, 10094592
    s_lshl_b32 s68, s66, 5
    s_add_u32 s68, s68, 10098688
    s_lshl_b32 s11, s4, 13
    s_lshl_b32 s12, s6, 7
    s_add_u32 s11, s11, s12
    s_add_u32 s11, s11, 10223616
    s_lshl_b32 s12, s4, 8
    s_lshl_b32 s13, s6, 2
    s_add_u32 s12, s12, s13
    s_add_u32 s12, s12, 10756064
    s_sub_i32 s14, 8, s6
    s_max_i32 s14, s14, 0
    s_mov_b32 s58, 65535
    s_mov_b32 s59, 65535
    s_waitcnt lgkmcnt(0)
    s_mov_b32 s40, s38
    s_mov_b32 s41, s39
    s_mov_b32 s42, 34603008
    s_mov_b32 s43, 131072
    s_buffer_load_dwordx8 s[48:55], s[40:43], s12
    s_add_u32 s12, s12, 32
    s_buffer_load_dword s56, s[40:43], s12
    s_lshl_b32 s7, s5, 3
    s_lshl_b32 s13, s3, 1
    s_add_i32 s7, s7, s13
    s_add_i32 s7, s7, -8
    s_max_i32 s7, s7, 0
    s_lshl_b32 s7, s7, 10
    s_add_u32 s7, s7, s9
    s_add_u32 m0, s8, 0
    s_add_u32 s13, s7, 3670016
    buffer_load_dwordx4 v2, s[40:43], s13 offen lds
    buffer_load_dwordx4 v2, s[40:43], s13 offen offset:1024 lds
    buffer_load_dwordx4 v[16:19], v2, s[40:43], s10 offen
    buffer_load_dword v244, v12, s[40:43], s11 offen
    s_add_u32 m0, s8, 16384
    s_add_u32 s13, s7, 5767168
    buffer_load_dwordx4 v2, s[40:43], s13 offen lds
    buffer_load_dwordx4 v2, s[40:43], s13 offen offset:1024 lds
    buffer_load_dwordx4 v[80:83], v14, s[40:43], s67 offen
    buffer_load_dwordx4 v[84:87], v14, s[40:43], s67 offen offset:16
    buffer_load_dwordx4 v[88:91], v15, s[40:43], s68 offen
    v_and_b32 v10, 31, v1
    v_lshlrev_b32 v11, 2, v3
    v_sub_u32 v10, v10, v11
    v_mov_b32 v11, 4048155338
    v_cmp_le_i32 s[60:61], 0, v10
    v_cmp_le_i32 s[62:63], 1, v10
    s_nop 0
    v_cndmask_b32 v224, v11, 0, s[60:61]
    v_cndmask_b32 v225, v11, 0, s[62:63]
    v_cmp_le_i32 s[60:61], 2, v10
    v_cmp_le_i32 s[62:63], 3, v10
    s_nop 0
    v_cndmask_b32 v226, v11, 0, s[60:61]
    v_cndmask_b32 v227, v11, 0, s[62:63]
    v_cmp_le_i32 s[60:61], 8, v10
    v_cmp_le_i32 s[62:63], 9, v10
    s_nop 0
    v_cndmask_b32 v228, v11, 0, s[60:61]
    v_cndmask_b32 v229, v11, 0, s[62:63]
    v_cmp_le_i32 s[60:61], 10, v10
    v_cmp_le_i32 s[62:63], 11, v10
    s_nop 0
    v_cndmask_b32 v230, v11, 0, s[60:61]
    v_cndmask_b32 v231, v11, 0, s[62:63]
    v_cmp_le_i32 s[60:61], 16, v10
    v_cmp_le_i32 s[62:63], 17, v10
    s_nop 0
    v_cndmask_b32 v232, v11, 0, s[60:61]
    v_cndmask_b32 v233, v11, 0, s[62:63]
    v_cmp_le_i32 s[60:61], 18, v10
    v_cmp_le_i32 s[62:63], 19, v10
    s_nop 0
    v_cndmask_b32 v234, v11, 0, s[60:61]
    v_cndmask_b32 v235, v11, 0, s[62:63]
    v_cmp_le_i32 s[60:61], 24, v10
    v_cmp_le_i32 s[62:63], 25, v10
    s_nop 0
    v_cndmask_b32 v236, v11, 0, s[60:61]
    v_cndmask_b32 v237, v11, 0, s[62:63]
    v_cmp_le_i32 s[60:61], 26, v10
    v_cmp_le_i32 s[62:63], 27, v10
    s_nop 0
    v_cndmask_b32 v238, v11, 0, s[60:61]
    v_cndmask_b32 v239, v11, 0, s[62:63]
    v_mov_b32 v56, 1065369472
    v_mov_b32 v57, 1065369472
    v_mov_b32 v58, 1065369472
    v_mov_b32 v59, 1065369472
    v_mov_b32 v60, 1065369472
    v_mov_b32 v61, 1065369472
    v_mov_b32 v62, 1065369472
    v_mov_b32 v63, 1065369472
    v_mov_b32 v64, 1065369472
    v_mov_b32 v65, 1065369472
    v_mov_b32 v66, 1065369472
    v_mov_b32 v67, 1065369472
    v_mov_b32 v68, 1065369472
    v_mov_b32 v69, 1065369472
    v_mov_b32 v70, 1065369472
    v_mov_b32 v71, 1065369472
    v_mov_b32 v72, 1065369472
    v_mov_b32 v73, 1065369472
    v_mov_b32 v74, 1065369472
    v_mov_b32 v75, 1065369472
    v_mov_b32 v76, 1065369472
    v_mov_b32 v77, 1065369472
    v_mov_b32 v78, 1065369472
    v_mov_b32 v79, 1065369472
    s_lshl_b32 s13, s3, 10
    v_add_u32 v246, s13, v2
    v_add_u32 v247, s13, v13
    s_waitcnt lgkmcnt(0)
    s_max_u32 s48, s48, s49
    s_max_u32 s48, s48, s50
    s_max_u32 s48, s48, s51
    s_max_u32 s48, s48, s52
    s_max_u32 s48, s48, s53
    s_max_u32 s48, s48, s54
    s_max_u32 s48, s48, s55
    s_max_u32 s48, s48, s56
    s_waitcnt vmcnt(5)
    v_mul_f32 v244, s48, v244
    v_sqrt_f32 v244, v244
    s_nop 0
    v_sub_f32 v208, 0, v244
    v_sub_f32 v209, 0, v244
    v_sub_f32 v210, 0, v244
    v_sub_f32 v211, 0, v244
    v_sub_f32 v212, 0, v244
    v_sub_f32 v213, 0, v244
    v_sub_f32 v214, 0, v244
    v_sub_f32 v215, 0, v244
    v_sub_f32 v216, 0, v244
    v_sub_f32 v217, 0, v244
    v_sub_f32 v218, 0, v244
    v_sub_f32 v219, 0, v244
    v_sub_f32 v220, 0, v244
    v_sub_f32 v221, 0, v244
    v_sub_f32 v222, 0, v244
    v_sub_f32 v223, 0, v244
    v_add_f32 v160, v224, v208
    v_add_f32 v161, v225, v208
    v_add_f32 v162, v226, v208
    v_add_f32 v163, v227, v208
    v_add_f32 v164, v228, v208
    v_add_f32 v165, v229, v208
    v_add_f32 v166, v230, v208
    v_add_f32 v167, v231, v208
    v_add_f32 v168, v232, v208
    v_add_f32 v169, v233, v208
    v_add_f32 v170, v234, v208
    v_add_f32 v171, v235, v208
    v_add_f32 v172, v236, v208
    v_add_f32 v173, v237, v208
    v_add_f32 v174, v238, v208
    v_add_f32 v175, v239, v208
    s_waitcnt vmcnt(3)
    s_barrier
    ds_read_b128 v[52:55], v246 offset:8192
    ds_read_b128 v[48:51], v246 offset:7168
    ds_read_b128 v[44:47], v246 offset:6144
    ds_read_b128 v[40:43], v246 offset:5120
    ds_read_b128 v[36:39], v246 offset:4096
    ds_read_b128 v[32:35], v246 offset:3072
    ds_read_b128 v[28:31], v246 offset:2048
    ds_read_b128 v[24:27], v246 offset:1024
    ds_read_b128 v[20:23], v246 offset:0
    s_getpc_b64 s[44:45]
L_pc_k2_attn_kernel:
    s_lshr_b32 s46, s2, 3
    s_mul_i32 s46, s46, 8
    s_add_u32 s46, s46, s3
    s_lshl_b32 s46, s46, 13
    v_lshlrev_b32 v8, 7, v1
    v_add_u32 v8, s46, v8
    v_min_u32 v8, k4_ffn1_kernel-k3_wo_kernel-4, v8
    v_add_u32 v8, k3_wo_kernel-L_pc_k2_attn_kernel, v8
    global_load_dword v249, v8, s[44:45]
    v_lshrrev_b32 v8, 3, v1
    v_and_b32 v9, 7, v1
    v_lshlrev_b32 v9, 4, v9
    v_lshl_add_u32 v248, v8, 10, v9
    v_mul_u32_u24 v8, 3584, v8
    v_add_u32 v8, v8, v9
    s_lshl_b32 s69, s3, 12
    s_add_u32 s69, s69, 32768
    s_cmp_eq_u32 s64, 0
    s_cbranch_scc0 L_k2_sl1
    s_mul_i32 s15, s66, 57344
    s_lshl_b32 s60, s65, 7
    s_add_u32 s15, s15, s60
    s_add_u32 s60, s15, 28672
    s_mov_b32 s44, s24
    s_mov_b32 s45, s25
    s_mov_b32 s46, 1835008
    s_mov_b32 s47, 131072
    s_add_u32 m0, s69, 0
    s_nop 0
    buffer_load_dwordx4 v8, s[44:47], s15 offen lds
    s_add_u32 m0, s69, 1024
    s_nop 0
    buffer_load_dwordx4 v8, s[44:47], s60 offen lds
    s_mov_b32 s44, s26
    s_mov_b32 s45, s27
    s_mov_b32 s46, 1835008
    s_mov_b32 s47, 131072
    s_add_u32 m0, s69, 2048
    s_nop 0
    buffer_load_dwordx4 v8, s[44:47], s15 offen lds
    s_add_u32 m0, s69, 3072
    s_nop 0
    buffer_load_dwordx4 v8, s[44:47], s60 offen lds
    s_branch L_k2_sl2
L_k2_sl1:
    s_cmp_eq_u32 s3, 7
    s_cselect_b32 s44, s20, s28
    s_cselect_b32 s45, s21, s29
    s_mov_b32 s13, 1835008
    s_cselect_b32 s46, 524288, s13
    s_mov_b32 s47, 131072
    s_lshr_b32 s12, s57, 3
    s_lshl_b32 s12, s12, 14
    s_and_b32 s13, s57, 7
    s_lshl_b32 s13, s13, 7
    s_add_u32 s12, s12, s13
    s_mov_b32 m0, s69
    s_nop 0
    buffer_load_dwordx4 v248, s[44:47], s12 offen lds
    s_add_u32 m0, s69, 1024
    s_add_u32 s12, s12, 8192
    buffer_load_dwordx4 v248, s[44:47], s12 offen lds
L_k2_sl2:
    s_mov_b64 exec, s[58:59]
    ds_read_b128 v[72:75], v247 offset:24576
    ds_read_b128 v[76:79], v247 offset:25088
    s_mov_b64 exec, -1
    s_mov_b64 exec, s[58:59]
    ds_read_b128 v[64:67], v247 offset:23552
    ds_read_b128 v[68:71], v247 offset:24064
    s_mov_b64 exec, -1
    s_waitcnt lgkmcnt(11)
    v_mfma_f32_32x32x16_bf16 v[160:175], v[52:55], v[16:19], v[160:175]
    v_mfma_f32_32x32x16_bf16 v[144:159], v[48:51], v[16:19], v[208:223]
    s_waitcnt lgkmcnt(4)
    v_mfma_f32_32x32x16_bf16 v[128:143], v[44:47], v[16:19], v[208:223]
    s_mov_b64 exec, s[58:59]
    ds_read_b128 v[56:59], v247 offset:22528
    ds_read_b128 v[60:63], v247 offset:23040
    s_mov_b64 exec, -1
    s_nop 4
    v_exp_f32 v160, v160
    v_exp_f32 v161, v161
    v_exp_f32 v162, v162
    v_exp_f32 v163, v163
    v_exp_f32 v164, v164
    v_exp_f32 v165, v165
    v_exp_f32 v166, v166
    v_exp_f32 v167, v167
    v_exp_f32 v168, v168
    v_cvt_pk_bf16_f32 v176, v160, v161
    v_exp_f32 v169, v169
    v_cvt_pk_bf16_f32 v177, v162, v163
    v_exp_f32 v170, v170
    v_cvt_pk_bf16_f32 v178, v164, v165
    v_exp_f32 v171, v171
    v_cvt_pk_bf16_f32 v179, v166, v167
    v_exp_f32 v172, v172
    v_exp_f32 v173, v173
    s_waitcnt lgkmcnt(4)
    v_mfma_f32_32x32x16_bf16 v[192:207], v[72:75], v[176:179], 0
    v_exp_f32 v174, v174
    v_exp_f32 v175, v175
    v_cvt_pk_bf16_f32 v180, v168, v169
    v_cvt_pk_bf16_f32 v181, v170, v171
    v_cvt_pk_bf16_f32 v182, v172, v173
    v_cvt_pk_bf16_f32 v183, v174, v175
    v_mfma_f32_32x32x16_bf16 v[160:175], v[40:43], v[16:19], v[208:223]
    s_cmp_eq_u32 s14, 8
    v_mfma_f32_32x32x16_bf16 v[192:207], v[76:79], v[180:183], v[192:207]
    s_cbranch_scc1 L_k2_p2a
    s_mov_b64 exec, s[58:59]
    ds_read_b128 v[72:75], v247 offset:21504
    ds_read_b128 v[76:79], v247 offset:22016
    s_mov_b64 exec, -1
    v_exp_f32 v144, v144
    v_exp_f32 v145, v145
    v_exp_f32 v146, v146
    v_exp_f32 v147, v147
    v_exp_f32 v148, v148
    v_exp_f32 v149, v149
    v_exp_f32 v150, v150
    v_exp_f32 v151, v151
    v_exp_f32 v152, v152
    v_cvt_pk_bf16_f32 v184, v144, v145
    v_exp_f32 v153, v153
    v_cvt_pk_bf16_f32 v185, v146, v147
    v_exp_f32 v154, v154
    v_cvt_pk_bf16_f32 v186, v148, v149
    v_exp_f32 v155, v155
    v_cvt_pk_bf16_f32 v187, v150, v151
    v_exp_f32 v156, v156
    v_exp_f32 v157, v157
    s_waitcnt lgkmcnt(4)
    v_mfma_f32_32x32x16_bf16 v[192:207], v[64:67], v[184:187], v[192:207]
    v_exp_f32 v158, v158
    v_exp_f32 v159, v159
    v_cvt_pk_bf16_f32 v188, v152, v153
    v_cvt_pk_bf16_f32 v189, v154, v155
    v_cvt_pk_bf16_f32 v190, v156, v157
    v_cvt_pk_bf16_f32 v191, v158, v159
    v_mfma_f32_32x32x16_bf16 v[144:159], v[36:39], v[16:19], v[208:223]
    s_cmp_eq_u32 s14, 7
    v_mfma_f32_32x32x16_bf16 v[192:207], v[68:71], v[188:191], v[192:207]
    s_cbranch_scc1 L_k2_p2a
    s_mov_b64 exec, s[58:59]
    ds_read_b128 v[64:67], v247 offset:20480
    ds_read_b128 v[68:71], v247 offset:20992
    s_mov_b64 exec, -1
    v_exp_f32 v128, v128
    v_exp_f32 v129, v129
    v_exp_f32 v130, v130
    v_exp_f32 v131, v131
    v_exp_f32 v132, v132
    v_exp_f32 v133, v133
    v_exp_f32 v134, v134
    v_exp_f32 v135, v135
    v_exp_f32 v136, v136
    v_cvt_pk_bf16_f32 v176, v128, v129
    v_exp_f32 v137, v137
    v_cvt_pk_bf16_f32 v177, v130, v131
    v_exp_f32 v138, v138
    v_cvt_pk_bf16_f32 v178, v132, v133
    v_exp_f32 v139, v139
    v_cvt_pk_bf16_f32 v179, v134, v135
    v_exp_f32 v140, v140
    v_exp_f32 v141, v141
    s_waitcnt lgkmcnt(4)
    v_mfma_f32_32x32x16_bf16 v[192:207], v[56:59], v[176:179], v[192:207]
    v_exp_f32 v142, v142
    v_exp_f32 v143, v143
    v_cvt_pk_bf16_f32 v180, v136, v137
    v_cvt_pk_bf16_f32 v181, v138, v139
    v_cvt_pk_bf16_f32 v182, v140, v141
    v_cvt_pk_bf16_f32 v183, v142, v143
    v_mfma_f32_32x32x16_bf16 v[128:143], v[32:35], v[16:19], v[208:223]
    s_cmp_eq_u32 s14, 6
    v_mfma_f32_32x32x16_bf16 v[192:207], v[60:63], v[180:183], v[192:207]
    s_cbranch_scc1 L_k2_p2a
    s_mov_b64 exec, s[58:59]
    ds_read_b128 v[56:59], v247 offset:19456
    ds_read_b128 v[60:63], v247 offset:19968
    s_mov_b64 exec, -1
    v_exp_f32 v160, v160
    v_exp_f32 v161, v161
    v_exp_f32 v162, v162
    v_exp_f32 v163, v163
    v_exp_f32 v164, v164
    v_exp_f32 v165, v165
    v_exp_f32 v166, v166
    v_exp_f32 v167, v167
    v_exp_f32 v168, v168
    v_cvt_pk_bf16_f32 v184, v160, v161
    v_exp_f32 v169, v169
    v_cvt_pk_bf16_f32 v185, v162, v163
    v_exp_f32 v170, v170
    v_cvt_pk_bf16_f32 v186, v164, v165
    v_exp_f32 v171, v171
    v_cvt_pk_bf16_f32 v187, v166, v167
    v_exp_f32 v172, v172
    v_exp_f32 v173, v173
    s_waitcnt lgkmcnt(4)
    v_mfma_f32_32x32x16_bf16 v[192:207], v[72:75], v[184:187], v[192:207]
    v_exp_f32 v174, v174
    v_exp_f32 v175, v175
    v_cvt_pk_bf16_f32 v188, v168, v169
    v_cvt_pk_bf16_f32 v189, v170, v171
    v_cvt_pk_bf16_f32 v190, v172, v173
    v_cvt_pk_bf16_f32 v191, v174, v175
    v_mfma_f32_32x32x16_bf16 v[160:175], v[28:31], v[16:19], v[208:223]
    s_cmp_eq_u32 s14, 5
    v_mfma_f32_32x32x16_bf16 v[192:207], v[76:79], v[188:191], v[192:207]
    s_cbranch_scc1 L_k2_p2a
    s_mov_b64 exec, s[58:59]
    ds_read_b128 v[72:75], v247 offset:18432
    ds_read_b128 v[76:79], v247 offset:18944
    s_mov_b64 exec, -1
    v_exp_f32 v144, v144
    v_exp_f32 v145, v145
    v_exp_f32 v146, v146
    v_exp_f32 v147, v147
    v_exp_f32 v148, v148
    v_exp_f32 v149, v149
    v_exp_f32 v150, v150
    v_exp_f32 v151, v151
    v_exp_f32 v152, v152
    v_cvt_pk_bf16_f32 v176, v144, v145
    v_exp_f32 v153, v153
    v_cvt_pk_bf16_f32 v177, v146, v147
    v_exp_f32 v154, v154
    v_cvt_pk_bf16_f32 v178, v148, v149
    v_exp_f32 v155, v155
    v_cvt_pk_bf16_f32 v179, v150, v151
    v_exp_f32 v156, v156
    v_exp_f32 v157, v157
    s_waitcnt lgkmcnt(4)
    v_mfma_f32_32x32x16_bf16 v[192:207], v[64:67], v[176:179], v[192:207]
    v_exp_f32 v158, v158
    v_exp_f32 v159, v159
    v_cvt_pk_bf16_f32 v180, v152, v153
    v_cvt_pk_bf16_f32 v181, v154, v155
    v_cvt_pk_bf16_f32 v182, v156, v157
    v_cvt_pk_bf16_f32 v183, v158, v159
    v_mfma_f32_32x32x16_bf16 v[144:159], v[24:27], v[16:19], v[208:223]
    s_cmp_eq_u32 s14, 4
    v_mfma_f32_32x32x16_bf16 v[192:207], v[68:71], v[180:183], v[192:207]
    s_cbranch_scc1 L_k2_p2a
    s_mov_b64 exec, s[58:59]
    ds_read_b128 v[64:67], v247 offset:17408
    ds_read_b128 v[68:71], v247 offset:17920
    s_mov_b64 exec, -1
    v_exp_f32 v128, v128
    v_exp_f32 v129, v129
    v_exp_f32 v130, v130
    v_exp_f32 v131, v131
    v_exp_f32 v132, v132
    v_exp_f32 v133, v133
    v_exp_f32 v134, v134
    v_exp_f32 v135, v135
    v_exp_f32 v136, v136
    v_cvt_pk_bf16_f32 v184, v128, v129
    v_exp_f32 v137, v137
    v_cvt_pk_bf16_f32 v185, v130, v131
    v_exp_f32 v138, v138
    v_cvt_pk_bf16_f32 v186, v132, v133
    v_exp_f32 v139, v139
    v_cvt_pk_bf16_f32 v187, v134, v135
    v_exp_f32 v140, v140
    v_exp_f32 v141, v141
    s_waitcnt lgkmcnt(4)
    v_mfma_f32_32x32x16_bf16 v[192:207], v[56:59], v[184:187], v[192:207]
    v_exp_f32 v142, v142
    v_exp_f32 v143, v143
    v_cvt_pk_bf16_f32 v188, v136, v137
    v_cvt_pk_bf16_f32 v189, v138, v139
    v_cvt_pk_bf16_f32 v190, v140, v141
    v_cvt_pk_bf16_f32 v191, v142, v143
    v_sub_f32 v128, v11, v224
    v_sub_f32 v129, v11, v225
    v_sub_f32 v130, v11, v226
    v_sub_f32 v131, v11, v227
    v_sub_f32 v132, v11, v228
    v_sub_f32 v133, v11, v229
    v_sub_f32 v134, v11, v230
    v_sub_f32 v135, v11, v231
    v_sub_f32 v136, v11, v232
    v_sub_f32 v137, v11, v233
    v_sub_f32 v138, v11, v234
    v_sub_f32 v139, v11, v235
    v_sub_f32 v140, v11, v236
    v_sub_f32 v141, v11, v237
    v_sub_f32 v142, v11, v238
    v_sub_f32 v143, v11, v239
    v_add_f32 v128, v128, v208
    v_add_f32 v129, v129, v208
    v_add_f32 v130, v130, v208
    v_add_f32 v131, v131, v208
    v_add_f32 v132, v132, v208
    v_add_f32 v133, v133, v208
    v_add_f32 v134, v134, v208
    v_add_f32 v135, v135, v208
    v_add_f32 v136, v136, v208
    v_add_f32 v137, v137, v208
    v_add_f32 v138, v138, v208
    v_add_f32 v139, v139, v208
    v_add_f32 v140, v140, v208
    v_add_f32 v141, v141, v208
    v_add_f32 v142, v142, v208
    v_add_f32 v143, v143, v208
    s_nop 1
    v_mfma_f32_32x32x16_bf16 v[128:143], v[20:23], v[16:19], v[128:143]
    s_cmp_eq_u32 s14, 3
    v_mfma_f32_32x32x16_bf16 v[192:207], v[60:63], v[188:191], v[192:207]
    s_cbranch_scc1 L_k2_p2a
    s_mov_b64 exec, s[58:59]
    ds_read_b128 v[56:59], v247 offset:16384
    ds_read_b128 v[60:63], v247 offset:16896
    s_mov_b64 exec, -1
    v_exp_f32 v160, v160
    v_exp_f32 v161, v161
    v_exp_f32 v162, v162
    v_exp_f32 v163, v163
    v_exp_f32 v164, v164
    v_exp_f32 v165, v165
    v_exp_f32 v166, v166
    v_exp_f32 v167, v167
    v_exp_f32 v168, v168
    v_cvt_pk_bf16_f32 v176, v160, v161
    v_exp_f32 v169, v169
    v_cvt_pk_bf16_f32 v177, v162, v163
    v_exp_f32 v170, v170
    v_cvt_pk_bf16_f32 v178, v164, v165
    v_exp_f32 v171, v171
    v_cvt_pk_bf16_f32 v179, v166, v167
    v_exp_f32 v172, v172
    v_exp_f32 v173, v173
    s_waitcnt lgkmcnt(4)
    v_mfma_f32_32x32x16_bf16 v[192:207], v[72:75], v[176:179], v[192:207]
    v_exp_f32 v174, v174
    v_exp_f32 v175, v175
    v_cvt_pk_bf16_f32 v180, v168, v169
    v_cvt_pk_bf16_f32 v181, v170, v171
    v_cvt_pk_bf16_f32 v182, v172, v173
    v_cvt_pk_bf16_f32 v183, v174, v175
    s_cmp_eq_u32 s14, 2
    s_nop 0
    v_mfma_f32_32x32x16_bf16 v[192:207], v[76:79], v[180:183], v[192:207]
    s_cbranch_scc1 L_k2_p2a
    v_exp_f32 v144, v144
    v_exp_f32 v145, v145
    v_exp_f32 v146, v146
    v_exp_f32 v147, v147
    v_exp_f32 v148, v148
    v_exp_f32 v149, v149
    v_exp_f32 v150, v150
    v_exp_f32 v151, v151
    v_exp_f32 v152, v152
    v_cvt_pk_bf16_f32 v184, v144, v145
    v_exp_f32 v153, v153
    v_cvt_pk_bf16_f32 v185, v146, v147
    v_exp_f32 v154, v154
    v_cvt_pk_bf16_f32 v186, v148, v149
    v_exp_f32 v155, v155
    v_cvt_pk_bf16_f32 v187, v150, v151
    v_exp_f32 v156, v156
    v_exp_f32 v157, v157
    s_waitcnt lgkmcnt(2)
    v_mfma_f32_32x32x16_bf16 v[192:207], v[64:67], v[184:187], v[192:207]
    v_exp_f32 v158, v158
    v_exp_f32 v159, v159
    v_cvt_pk_bf16_f32 v188, v152, v153
    v_cvt_pk_bf16_f32 v189, v154, v155
    v_cvt_pk_bf16_f32 v190, v156, v157
    v_cvt_pk_bf16_f32 v191, v158, v159
    s_cmp_eq_u32 s14, 1
    s_nop 0
    v_mfma_f32_32x32x16_bf16 v[192:207], v[68:71], v[188:191], v[192:207]
    s_cbranch_scc1 L_k2_p2a
    v_exp_f32 v128, v128
    v_exp_f32 v129, v129
    v_exp_f32 v130, v130
    v_exp_f32 v131, v131
    v_exp_f32 v132, v132
    v_exp_f32 v133, v133
    v_exp_f32 v134, v134
    v_exp_f32 v135, v135
    v_exp_f32 v136, v136
    v_cvt_pk_bf16_f32 v176, v128, v129
    v_exp_f32 v137, v137
    v_cvt_pk_bf16_f32 v177, v130, v131
    v_exp_f32 v138, v138
    v_cvt_pk_bf16_f32 v178, v132, v133
    v_exp_f32 v139, v139
    v_cvt_pk_bf16_f32 v179, v134, v135
    v_exp_f32 v140, v140
    v_exp_f32 v141, v141
    s_waitcnt lgkmcnt(0)
    v_mfma_f32_32x32x16_bf16 v[192:207], v[56:59], v[176:179], v[192:207]
    v_exp_f32 v142, v142
    v_exp_f32 v143, v143
    v_cvt_pk_bf16_f32 v180, v136, v137
    v_cvt_pk_bf16_f32 v181, v138, v139
    v_cvt_pk_bf16_f32 v182, v140, v141
    v_cvt_pk_bf16_f32 v183, v142, v143
    s_nop 1
    v_mfma_f32_32x32x16_bf16 v[192:207], v[60:63], v[180:183], v[192:207]
    s_nop 11
L_k2_p2a:
    s_nop 11
    s_waitcnt lgkmcnt(0)
    v_mov_b32 v244, 394264576
    v_cmp_nge_f32 vcc, v200, v244
    s_nop 4
    s_cbranch_vccz L_k2_fin
    s_mov_b64 exec, s[58:59]
    ds_read_b128 v[72:75], v247 offset:24576
    ds_read_b128 v[76:79], v247 offset:25088
    s_mov_b64 exec, -1
    s_mov_b64 exec, s[58:59]
    ds_read_b128 v[64:67], v247 offset:23552
    ds_read_b128 v[68:71], v247 offset:24064
    s_mov_b64 exec, -1
    v_mfma_f32_32x32x16_bf16 v[160:175], v[52:55], v[16:19], v[224:239]
    v_mfma_f32_32x32x16_bf16 v[144:159], v[48:51], v[16:19], 0
    v_mfma_f32_32x32x16_bf16 v[128:143], v[44:47], v[16:19], 0
    s_nop 9
    v_max3_f32 v244, v160, v161, v162
    v_max3_f32 v245, v163, v164, v165
    v_max3_f32 v244, v244, v166, v167
    v_max3_f32 v245, v245, v168, v169
    v_max3_f32 v244, v244, v170, v171
    v_max3_f32 v245, v245, v172, v173
    v_max3_f32 v244, v244, v174, v175
    s_cmp_eq_u32 s14, 8
    s_cbranch_scc1 L_k2_p1x
    v_mfma_f32_32x32x16_bf16 v[160:175], v[40:43], v[16:19], 0
    v_max3_f32 v244, v244, v144, v145
    v_max3_f32 v245, v245, v146, v147
    v_max3_f32 v244, v244, v148, v149
    v_max3_f32 v245, v245, v150, v151
    v_max3_f32 v244, v244, v152, v153
    v_max3_f32 v245, v245, v154, v155
    v_max3_f32 v244, v244, v156, v157
    v_max3_f32 v245, v245, v158, v159
    s_cmp_eq_u32 s14, 7
    s_cbranch_scc1 L_k2_p1x
    v_mfma_f32_32x32x16_bf16 v[144:159], v[36:39], v[16:19], 0
    v_max3_f32 v244, v244, v128, v129
    v_max3_f32 v245, v245, v130, v131
    v_max3_f32 v244, v244, v132, v133
    v_max3_f32 v245, v245, v134, v135
    v_max3_f32 v244, v244, v136, v137
    v_max3_f32 v245, v245, v138, v139
    v_max3_f32 v244, v244, v140, v141
    v_max3_f32 v245, v245, v142, v143
    s_cmp_eq_u32 s14, 6
    s_cbranch_scc1 L_k2_p1x
    v_mfma_f32_32x32x16_bf16 v[128:143], v[32:35], v[16:19], 0
    v_max3_f32 v244, v244, v160, v161
    v_max3_f32 v245, v245, v162, v163
    v_max3_f32 v244, v244, v164, v165
    v_max3_f32 v245, v245, v166, v167
    v_max3_f32 v244, v244, v168, v169
    v_max3_f32 v245, v245, v170, v171
    v_max3_f32 v244, v244, v172, v173
    v_max3_f32 v245, v245, v174, v175
    s_cmp_eq_u32 s14, 5
    s_cbranch_scc1 L_k2_p1x
    v_mfma_f32_32x32x16_bf16 v[160:175], v[28:31], v[16:19], 0
    v_max3_f32 v244, v244, v144, v145
    v_max3_f32 v245, v245, v146, v147
    v_max3_f32 v244, v244, v148, v149
    v_max3_f32 v245, v245, v150, v151
    v_max3_f32 v244, v244, v152, v153
    v_max3_f32 v245, v245, v154, v155
    v_max3_f32 v244, v244, v156, v157
    v_max3_f32 v245, v245, v158, v159
    s_cmp_eq_u32 s14, 4
    s_cbranch_scc1 L_k2_p1x
    v_mfma_f32_32x32x16_bf16 v[144:159], v[24:27], v[16:19], 0
    v_max3_f32 v244, v244, v128, v129
    v_max3_f32 v245, v245, v130, v131
    v_max3_f32 v244, v244, v132, v133
    v_max3_f32 v245, v245, v134, v135
    v_max3_f32 v244, v244, v136, v137
    v_max3_f32 v245, v245, v138, v139
    v_max3_f32 v244, v244, v140, v141
    v_max3_f32 v245, v245, v142, v143
    s_cmp_eq_u32 s14, 3
    s_cbranch_scc1 L_k2_p1x
    v_sub_f32 v128, v11, v224
    v_sub_f32 v129, v11, v225
    v_sub_f32 v130, v11, v226
    v_sub_f32 v131, v11, v227
    v_sub_f32 v132, v11, v228
    v_sub_f32 v133, v11, v229
    v_sub_f32 v134, v11, v230
    v_sub_f32 v135, v11, v231
    v_sub_f32 v136, v11, v232
    v_sub_f32 v137, v11, v233
    v_sub_f32 v138, v11, v234
    v_sub_f32 v139, v11, v235
    v_sub_f32 v140, v11, v236
    v_sub_f32 v141, v11, v237
    v_sub_f32 v142, v11, v238
    v_sub_f32 v143, v11, v239
    s_nop 1
    v_mfma_f32_32x32x16_bf16 v[128:143], v[20:23], v[16:19], v[128:143]
    v_max3_f32 v244, v244, v160, v161
    v_max3_f32 v245, v245, v162, v163
    v_max3_f32 v244, v244, v164, v165
    v_max3_f32 v245, v245, v166, v167
    v_max3_f32 v244, v244, v168, v169
    v_max3_f32 v245, v245, v170, v171
    v_max3_f32 v244, v244, v172, v173
    v_max3_f32 v245, v245, v174, v175
    s_cmp_eq_u32 s14, 2
    s_cbranch_scc1 L_k2_p1x
    v_max3_f32 v244, v244, v144, v145
    v_max3_f32 v245, v245, v146, v147
    v_max3_f32 v244, v244, v148, v149
    v_max3_f32 v245, v245, v150, v151
    v_max3_f32 v244, v244, v152, v153
    v_max3_f32 v245, v245, v154, v155
    v_max3_f32 v244, v244, v156, v157
    v_max3_f32 v245, v245, v158, v159
    s_cmp_eq_u32 s14, 1
    s_cbranch_scc1 L_k2_p1x
    v_max3_f32 v244, v244, v128, v129
    v_max3_f32 v245, v245, v130, v131
    v_max3_f32 v244, v244, v132, v133
    v_max3_f32 v245, v245, v134, v135
    v_max3_f32 v244, v244, v136, v137
    v_max3_f32 v245, v245, v138, v139
    v_max3_f32 v244, v244, v140, v141
    v_max3_f32 v245, v245, v142, v143
    s_nop 2
L_k2_p1x:
    s_nop 11
    v_max_f32 v244, v244, v245
    v_mov_b32 v245, v244
    s_nop 1
    v_permlane32_swap_b32 v244, v245
    v_max_f32 v244, v244, v245
    v_sub_f32 v208, 0, v244
    v_sub_f32 v209, 0, v244
    v_sub_f32 v210, 0, v244
    v_sub_f32 v211, 0, v244
    v_sub_f32 v212, 0, v244
    v_sub_f32 v213, 0, v244
    v_sub_f32 v214, 0, v244
    v_sub_f32 v215, 0, v244
    v_sub_f32 v216, 0, v244
    v_sub_f32 v217, 0, v244
    v_sub_f32 v218, 0, v244
    v_sub_f32 v219, 0, v244
    v_sub_f32 v220, 0, v244
    v_sub_f32 v221, 0, v244
    v_sub_f32 v222, 0, v244
    v_sub_f32 v223, 0, v244
    v_add_f32 v160, v224, v208
    v_add_f32 v161, v225, v208
    v_add_f32 v162, v226, v208
    v_add_f32 v163, v227, v208
    v_add_f32 v164, v228, v208
    v_add_f32 v165, v229, v208
    v_add_f32 v166, v230, v208
    v_add_f32 v167, v231, v208
    v_add_f32 v168, v232, v208
    v_add_f32 v169, v233, v208
    v_add_f32 v170, v234, v208
    v_add_f32 v171, v235, v208
    v_add_f32 v172, v236, v208
    v_add_f32 v173, v237, v208
    v_add_f32 v174, v238, v208
    v_add_f32 v175, v239, v208
    s_nop 1
    v_mfma_f32_32x32x16_bf16 v[160:175], v[52:55], v[16:19], v[160:175]
    v_mfma_f32_32x32x16_bf16 v[144:159], v[48:51], v[16:19], v[208:223]
    v_mfma_f32_32x32x16_bf16 v[128:143], v[44:47], v[16:19], v[208:223]
    s_mov_b64 exec, s[58:59]
    ds_read_b128 v[56:59], v247 offset:22528
    ds_read_b128 v[60:63], v247 offset:23040
    s_mov_b64 exec, -1
    s_nop 5
    v_exp_f32 v160, v160
    v_exp_f32 v161, v161
    v_exp_f32 v162, v162
    v_exp_f32 v163, v163
    v_exp_f32 v164, v164
    v_exp_f32 v165, v165
    v_exp_f32 v166, v166
    v_exp_f32 v167, v167
    v_exp_f32 v168, v168
    v_cvt_pk_bf16_f32 v176, v160, v161
    v_exp_f32 v169, v169
    v_cvt_pk_bf16_f32 v177, v162, v163
    v_exp_f32 v170, v170
    v_cvt_pk_bf16_f32 v178, v164, v165
    v_exp_f32 v171, v171
    v_cvt_pk_bf16_f32 v179, v166, v167
    v_exp_f32 v172, v172
    v_exp_f32 v173, v173
    s_waitcnt lgkmcnt(4)
    v_mfma_f32_32x32x16_bf16 v[192:207], v[72:75], v[176:179], 0
    v_exp_f32 v174, v174
    v_exp_f32 v175, v175
    v_cvt_pk_bf16_f32 v180, v168, v169
    v_cvt_pk_bf16_f32 v181, v170, v171
    v_cvt_pk_bf16_f32 v182, v172, v173
    v_cvt_pk_bf16_f32 v183, v174, v175
    v_mfma_f32_32x32x16_bf16 v[160:175], v[40:43], v[16:19], v[208:223]
    s_cmp_eq_u32 s14, 8
    v_mfma_f32_32x32x16_bf16 v[192:207], v[76:79], v[180:183], v[192:207]
    s_cbranch_scc1 L_k2_p2x
    s_mov_b64 exec, s[58:59]
    ds_read_b128 v[72:75], v247 offset:21504
    ds_read_b128 v[76:79], v247 offset:22016
    s_mov_b64 exec, -1
    v_exp_f32 v144, v144
    v_exp_f32 v145, v145
    v_exp_f32 v146, v146
    v_exp_f32 v147, v147
    v_exp_f32 v148, v148
    v_exp_f32 v149, v149
    v_exp_f32 v150, v150
    v_exp_f32 v151, v151
    v_exp_f32 v152, v152
    v_cvt_pk_bf16_f32 v184, v144, v145
    v_exp_f32 v153, v153
    v_cvt_pk_bf16_f32 v185, v146, v147
    v_exp_f32 v154, v154
    v_cvt_pk_bf16_f32 v186, v148, v149
    v_exp_f32 v155, v155
    v_cvt_pk_bf16_f32 v187, v150, v151
    v_exp_f32 v156, v156
    v_exp_f32 v157, v157
    s_waitcnt lgkmcnt(4)
    v_mfma_f32_32x32x16_bf16 v[192:207], v[64:67], v[184:187], v[192:207]
    v_exp_f32 v158, v158
    v_exp_f32 v159, v159
    v_cvt_pk_bf16_f32 v188, v152, v153
    v_cvt_pk_bf16_f32 v189, v154, v155
    v_cvt_pk_bf16_f32 v190, v156, v157
    v_cvt_pk_bf16_f32 v191, v158, v159
    v_mfma_f32_32x32x16_bf16 v[144:159], v[36:39], v[16:19], v[208:223]
    s_cmp_eq_u32 s14, 7
    v_mfma_f32_32x32x16_bf16 v[192:207], v[68:71], v[188:191], v[192:207]
    s_cbranch_scc1 L_k2_p2x
    s_mov_b64 exec, s[58:59]
    ds_read_b128 v[64:67], v247 offset:20480
    ds_read_b128 v[68:71], v247 offset:20992
    s_mov_b64 exec, -1
    v_exp_f32 v128, v128
    v_exp_f32 v129, v129
    v_exp_f32 v130, v130
    v_exp_f32 v131, v131
    v_exp_f32 v132, v132
    v_exp_f32 v133, v133
    v_exp_f32 v134, v134
    v_exp_f32 v135, v135
    v_exp_f32 v136, v136
    v_cvt_pk_bf16_f32 v176, v128, v129
    v_exp_f32 v137, v137
    v_cvt_pk_bf16_f32 v177, v130, v131
    v_exp_f32 v138, v138
    v_cvt_pk_bf16_f32 v178, v132, v133
    v_exp_f32 v139, v139
    v_cvt_pk_bf16_f32 v179, v134, v135
    v_exp_f32 v140, v140
    v_exp_f32 v141, v141
    s_waitcnt lgkmcnt(4)
    v_mfma_f32_32x32x16_bf16 v[192:207], v[56:59], v[176:179], v[192:207]
    v_exp_f32 v142, v142
    v_exp_f32 v143, v143
    v_cvt_pk_bf16_f32 v180, v136, v137
    v_cvt_pk_bf16_f32 v181, v138, v139
    v_cvt_pk_bf16_f32 v182, v140, v141
    v_cvt_pk_bf16_f32 v183, v142, v143
    v_mfma_f32_32x32x16_bf16 v[128:143], v[32:35], v[16:19], v[208:223]
    s_cmp_eq_u32 s14, 6
    v_mfma_f32_32x32x16_bf16 v[192:207], v[60:63], v[180:183], v[192:207]
    s_cbranch_scc1 L_k2_p2x
    s_mov_b64 exec, s[58:59]
    ds_read_b128 v[56:59], v247 offset:19456
    ds_read_b128 v[60:63], v247 offset:19968
    s_mov_b64 exec, -1
    v_exp_f32 v160, v160
    v_exp_f32 v161, v161
    v_exp_f32 v162, v162
    v_exp_f32 v163, v163
    v_exp_f32 v164, v164
    v_exp_f32 v165, v165
    v_exp_f32 v166, v166
    v_exp_f32 v167, v167
    v_exp_f32 v168, v168
    v_cvt_pk_bf16_f32 v184, v160, v161
    v_exp_f32 v169, v169
    v_cvt_pk_bf16_f32 v185, v162, v163
    v_exp_f32 v170, v170
    v_cvt_pk_bf16_f32 v186, v164, v165
    v_exp_f32 v171, v171
    v_cvt_pk_bf16_f32 v187, v166, v167
    v_exp_f32 v172, v172
    v_exp_f32 v173, v173
    s_waitcnt lgkmcnt(4)
    v_mfma_f32_32x32x16_bf16 v[192:207], v[72:75], v[184:187], v[192:207]
    v_exp_f32 v174, v174
    v_exp_f32 v175, v175
    v_cvt_pk_bf16_f32 v188, v168, v169
    v_cvt_pk_bf16_f32 v189, v170, v171
    v_cvt_pk_bf16_f32 v190, v172, v173
    v_cvt_pk_bf16_f32 v191, v174, v175
    v_mfma_f32_32x32x16_bf16 v[160:175], v[28:31], v[16:19], v[208:223]
    s_cmp_eq_u32 s14, 5
    v_mfma_f32_32x32x16_bf16 v[192:207], v[76:79], v[188:191], v[192:207]
    s_cbranch_scc1 L_k2_p2x
    s_mov_b64 exec, s[58:59]
    ds_read_b128 v[72:75], v247 offset:18432
    ds_read_b128 v[76:79], v247 offset:18944
    s_mov_b64 exec, -1
    v_exp_f32 v144, v144
    v_exp_f32 v145, v145
    v_exp_f32 v146, v146
    v_exp_f32 v147, v147
    v_exp_f32 v148, v148
    v_exp_f32 v149, v149
    v_exp_f32 v150, v150
    v_exp_f32 v151, v151
    v_exp_f32 v152, v152
    v_cvt_pk_bf16_f32 v176, v144, v145
    v_exp_f32 v153, v153
    v_cvt_pk_bf16_f32 v177, v146, v147
    v_exp_f32 v154, v154
    v_cvt_pk_bf16_f32 v178, v148, v149
    v_exp_f32 v155, v155
    v_cvt_pk_bf16_f32 v179, v150, v151
    v_exp_f32 v156, v156
    v_exp_f32 v157, v157
    s_waitcnt lgkmcnt(4)
    v_mfma_f32_32x32x16_bf16 v[192:207], v[64:67], v[176:179], v[192:207]
    v_exp_f32 v158, v158
    v_exp_f32 v159, v159
    v_cvt_pk_bf16_f32 v180, v152, v153
    v_cvt_pk_bf16_f32 v181, v154, v155
    v_cvt_pk_bf16_f32 v182, v156, v157
    v_cvt_pk_bf16_f32 v183, v158, v159
    v_mfma_f32_32x32x16_bf16 v[144:159], v[24:27], v[16:19], v[208:223]
    s_cmp_eq_u32 s14, 4
    v_mfma_f32_32x32x16_bf16 v[192:207], v[68:71], v[180:183], v[192:207]
    s_cbranch_scc1 L_k2_p2x
    s_mov_b64 exec, s[58:59]
    ds_read_b128 v[64:67], v247 offset:17408
    ds_read_b128 v[68:71], v247 offset:17920
    s_mov_b64 exec, -1
    v_exp_f32 v128, v128
    v_exp_f32 v129, v129
    v_exp_f32 v130, v130
    v_exp_f32 v131, v131
    v_exp_f32 v132, v132
    v_exp_f32 v133, v133
    v_exp_f32 v134, v134
    v_exp_f32 v135, v135
    v_exp_f32 v136, v136
    v_cvt_pk_bf16_f32 v184, v128, v129
    v_exp_f32 v137, v137
    v_cvt_pk_bf16_f32 v185, v130, v131
    v_exp_f32 v138, v138
    v_cvt_pk_bf16_f32 v186, v132, v133
    v_exp_f32 v139, v139
    v_cvt_pk_bf16_f32 v187, v134, v135
    v_exp_f32 v140, v140
    v_exp_f32 v141, v141
    s_waitcnt lgkmcnt(4)
    v_mfma_f32_32x32x16_bf16 v[192:207], v[56:59], v[184:187], v[192:207]
    v_exp_f32 v142, v142
    v_exp_f32 v143, v143
    v_cvt_pk_bf16_f32 v188, v136, v137
    v_cvt_pk_bf16_f32 v189, v138, v139
    v_cvt_pk_bf16_f32 v190, v140, v141
    v_cvt_pk_bf16_f32 v191, v142, v143
    v_sub_f32 v128, v11, v224
    v_sub_f32 v129, v11, v225
    v_sub_f32 v130, v11, v226
    v_sub_f32 v131, v11, v227
    v_sub_f32 v132, v11, v228
    v_sub_f32 v133, v11, v229
    v_sub_f32 v134, v11, v230
    v_sub_f32 v135, v11, v231
    v_sub_f32 v136, v11, v232
    v_sub_f32 v137, v11, v233
    v_sub_f32 v138, v11, v234
    v_sub_f32 v139, v11, v235
    v_sub_f32 v140, v11, v236
    v_sub_f32 v141, v11, v237
    v_sub_f32 v142, v11, v238
    v_sub_f32 v143, v11, v239
    v_add_f32 v128, v128, v208
    v_add_f32 v129, v129, v208
    v_add_f32 v130, v130, v208
    v_add_f32 v131, v131, v208
    v_add_f32 v132, v132, v208
    v_add_f32 v133, v133, v208
    v_add_f32 v134, v134, v208
    v_add_f32 v135, v135, v208
    v_add_f32 v136, v136, v208
    v_add_f32 v137, v137, v208
    v_add_f32 v138, v138, v208
    v_add_f32 v139, v139, v208
    v_add_f32 v140, v140, v208
    v_add_f32 v141, v141, v208
    v_add_f32 v142, v142, v208
    v_add_f32 v143, v143, v208
    s_nop 1
    v_mfma_f32_32x32x16_bf16 v[128:143], v[20:23], v[16:19], v[128:143]
    s_cmp_eq_u32 s14, 3
    v_mfma_f32_32x32x16_bf16 v[192:207], v[60:63], v[188:191], v[192:207]
    s_cbranch_scc1 L_k2_p2x
    s_mov_b64 exec, s[58:59]
    ds_read_b128 v[56:59], v247 offset:16384
    ds_read_b128 v[60:63], v247 offset:16896
    s_mov_b64 exec, -1
    v_exp_f32 v160, v160
    v_exp_f32 v161, v161
    v_exp_f32 v162, v162
    v_exp_f32 v163, v163
    v_exp_f32 v164, v164
    v_exp_f32 v165, v165
    v_exp_f32 v166, v166
    v_exp_f32 v167, v167
    v_exp_f32 v168, v168
    v_cvt_pk_bf16_f32 v176, v160, v161
    v_exp_f32 v169, v169
    v_cvt_pk_bf16_f32 v177, v162, v163
    v_exp_f32 v170, v170
    v_cvt_pk_bf16_f32 v178, v164, v165
    v_exp_f32 v171, v171
    v_cvt_pk_bf16_f32 v179, v166, v167
    v_exp_f32 v172, v172
    v_exp_f32 v173, v173
    s_waitcnt lgkmcnt(4)
    v_mfma_f32_32x32x16_bf16 v[192:207], v[72:75], v[176:179], v[192:207]
    v_exp_f32 v174, v174
    v_exp_f32 v175, v175
    v_cvt_pk_bf16_f32 v180, v168, v169
    v_cvt_pk_bf16_f32 v181, v170, v171
    v_cvt_pk_bf16_f32 v182, v172, v173
    v_cvt_pk_bf16_f32 v183, v174, v175
    s_cmp_eq_u32 s14, 2
    s_nop 0
    v_mfma_f32_32x32x16_bf16 v[192:207], v[76:79], v[180:183], v[192:207]
    s_cbranch_scc1 L_k2_p2x
    v_exp_f32 v144, v144
    v_exp_f32 v145, v145
    v_exp_f32 v146, v146
    v_exp_f32 v147, v147
    v_exp_f32 v148, v148
    v_exp_f32 v149, v149
    v_exp_f32 v150, v150
    v_exp_f32 v151, v151
    v_exp_f32 v152, v152
    v_cvt_pk_bf16_f32 v184, v144, v145
    v_exp_f32 v153, v153
    v_cvt_pk_bf16_f32 v185, v146, v147
    v_exp_f32 v154, v154
    v_cvt_pk_bf16_f32 v186, v148, v149
    v_exp_f32 v155, v155
    v_cvt_pk_bf16_f32 v187, v150, v151
    v_exp_f32 v156, v156
    v_exp_f32 v157, v157
    s_waitcnt lgkmcnt(2)
    v_mfma_f32_32x32x16_bf16 v[192:207], v[64:67], v[184:187], v[192:207]
    v_exp_f32 v158, v158
    v_exp_f32 v159, v159
    v_cvt_pk_bf16_f32 v188, v152, v153
    v_cvt_pk_bf16_f32 v189, v154, v155
    v_cvt_pk_bf16_f32 v190, v156, v157
    v_cvt_pk_bf16_f32 v191, v158, v159
    s_cmp_eq_u32 s14, 1
    s_nop 0
    v_mfma_f32_32x32x16_bf16 v[192:207], v[68:71], v[188:191], v[192:207]
    s_cbranch_scc1 L_k2_p2x
    v_exp_f32 v128, v128
    v_exp_f32 v129, v129
    v_exp_f32 v130, v130
    v_exp_f32 v131, v131
    v_exp_f32 v132, v132
    v_exp_f32 v133, v133
    v_exp_f32 v134, v134
    v_exp_f32 v135, v135
    v_exp_f32 v136, v136
    v_cvt_pk_bf16_f32 v176, v128, v129
    v_exp_f32 v137, v137
    v_cvt_pk_bf16_f32 v177, v130, v131
    v_exp_f32 v138, v138
    v_cvt_pk_bf16_f32 v178, v132, v133
    v_exp_f32 v139, v139
    v_cvt_pk_bf16_f32 v179, v134, v135
    v_exp_f32 v140, v140
    v_exp_f32 v141, v141
    s_waitcnt lgkmcnt(0)
    v_mfma_f32_32x32x16_bf16 v[192:207], v[56:59], v[176:179], v[192:207]
    v_exp_f32 v142, v142
    v_exp_f32 v143, v143
    v_cvt_pk_bf16_f32 v180, v136, v137
    v_cvt_pk_bf16_f32 v181, v138, v139
    v_cvt_pk_bf16_f32 v182, v140, v141
    v_cvt_pk_bf16_f32 v183, v142, v143
    s_nop 1
    v_mfma_f32_32x32x16_bf16 v[192:207], v[60:63], v[180:183], v[192:207]
    s_nop 11
L_k2_p2x:
    s_nop 11
    s_waitcnt lgkmcnt(0)
L_k2_fin:
    v_rcp_f32 v244, v200
    s_nop 0
    v_mul_f32 v192, v192, v244
    v_mul_f32 v193, v193, v244
    v_mul_f32 v194, v194, v244
    v_mul_f32 v195, v195, v244
    v_mul_f32 v196, v196, v244
    v_mul_f32 v197, v197, v244
    v_mul_f32 v198, v198, v244
    v_mul_f32 v199, v199, v244
    v_cvt_pk_bf16_f32 v176, v192, v193
    v_cvt_pk_bf16_f32 v177, v194, v195
    v_cvt_pk_bf16_f32 v178, v196, v197
    v_cvt_pk_bf16_f32 v179, v198, v199
    s_lshl_b32 s12, s6, 15
    s_lshl_b32 s13, s4, 10
    s_add_u32 s12, s12, s13
    s_add_u32 s12, s12, 19922944
    buffer_store_dwordx4 v[176:179], v2, s[40:43], s12 offen sc1
    s_waitcnt vmcnt(1)
    s_cmp_eq_u32 s64, 0
    s_cbranch_scc1 L_k2_gu
    s_mov_b32 s60, 1024
    s_mov_b32 s61, 512
    s_cmp_eq_u32 s3, 7
    s_cselect_b32 s12, 512, s60
    s_cselect_b32 s13, 1024, s61
    v_mul_lo_u32 v8, v3, s12
    v_lshl_add_u32 v8, v5, 7, v8
    v_lshl_add_u32 v8, v4, 5, v8
    v_lshl_add_u32 v8, v6, 3, v8
    v_add_u32 v8, s69, v8
    v_add_u32 v9, s13, v8
    ds_read_b64_tr_b16 v[20:21], v8 offset:0
    ds_read_b64_tr_b16 v[22:23], v9 offset:0
    ds_read_b64_tr_b16 v[24:25], v8 offset:64
    ds_read_b64_tr_b16 v[26:27], v9 offset:64
    s_mov_b32 s60, 114688
    s_cselect_b32 s60, 32768, s60
    s_mov_b32 s61, 17301504
    s_cselect_b32 s61, 16777216, s61
    s_and_b32 s12, s57, 7
    s_lshl_b32 s12, s12, 1
    s_mul_i32 s12, s12, s60
    s_add_u32 s61, s61, s12
    s_lshr_b32 s12, s57, 3
    s_lshl_b32 s12, s12, 10
    s_add_u32 s61, s61, s12
    s_add_u32 s62, s61, s60
    s_waitcnt lgkmcnt(0)
    buffer_store_dwordx4 v[20:23], v2, s[40:43], s61 offen sc1
    buffer_store_dwordx4 v[24:27], v2, s[40:43], s62 offen sc1
    s_branch L_k2_sw1
    s_nop 0
L_k2_gu:
    v_lshlrev_b32 v10, 11, v4
    v_lshl_add_u32 v11, v3, 3, v5
    v_lshl_add_u32 v10, v11, 7, v10
    v_lshl_add_u32 v10, v6, 3, v10
    v_add_u32 v10, s69, v10
    ds_read_b64_tr_b16 v[20:21], v10 offset:0
    ds_read_b64_tr_b16 v[22:23], v10 offset:512
    ds_read_b64_tr_b16 v[24:25], v10 offset:32
    ds_read_b64_tr_b16 v[26:27], v10 offset:544
    ds_read_b64_tr_b16 v[28:29], v10 offset:64
    ds_read_b64_tr_b16 v[30:31], v10 offset:576
    ds_read_b64_tr_b16 v[32:33], v10 offset:96
    ds_read_b64_tr_b16 v[34:35], v10 offset:608
    s_lshl_b32 s60, s65, 2
    s_mul_i32 s15, s66, 7168
    s_add_u32 s15, s15, 12582912
    s_add_u32 s12, s60, 0
    s_mul_i32 s13, s12, 147
    s_lshr_b32 s13, s13, 10
    s_mul_i32 s61, s13, 7
    s_sub_u32 s12, s12, s61
    s_mul_i32 s13, s13, 236544
    s_lshl_b32 s12, s12, 10
    s_add_u32 s12, s12, s13
    s_add_u32 s48, s12, s15
    s_add_u32 s12, s60, 1
    s_mul_i32 s13, s12, 147
    s_lshr_b32 s13, s13, 10
    s_mul_i32 s61, s13, 7
    s_sub_u32 s12, s12, s61
    s_mul_i32 s13, s13, 236544
    s_lshl_b32 s12, s12, 10
    s_add_u32 s12, s12, s13
    s_add_u32 s49, s12, s15
    s_add_u32 s12, s60, 2
    s_mul_i32 s13, s12, 147
    s_lshr_b32 s13, s13, 10
    s_mul_i32 s61, s13, 7
    s_sub_u32 s12, s12, s61
    s_mul_i32 s13, s13, 236544
    s_lshl_b32 s12, s12, 10
    s_add_u32 s12, s12, s13
    s_add_u32 s50, s12, s15
    s_add_u32 s12, s60, 3
    s_mul_i32 s13, s12, 147
    s_lshr_b32 s13, s13, 10
    s_mul_i32 s61, s13, 7
    s_sub_u32 s12, s12, s61
    s_mul_i32 s13, s13, 236544
    s_lshl_b32 s12, s12, 10
    s_add_u32 s12, s12, s13
    s_add_u32 s51, s12, s15
    v_mov_b32 v240, 1065369472
    v_mov_b32 v241, 1065369472
    v_mov_b32 v242, 1065369472
    v_mov_b32 v243, 1065369472
    s_mul_i32 s62, s66, 28672
    s_lshl_b32 s63, s60, 7
    s_add_u32 s62, s62, s63
    s_add_u32 s62, s62, 11534336
    v_mul_u32_u24 v8, 14336, v3
    v_add_u32 v8, v8, v12
    v_cmp_eq_u32 vcc, 0, v3
    s_waitcnt lgkmcnt(6)
    v_mfma_f32_32x32x16_bf16 v[96:111], v[88:91], v[20:23], 0
    v_lshlrev_b32 v224, 16, v20
    v_and_b32 v225, 4294901760, v20
    v_lshlrev_b32 v226, 16, v21
    v_and_b32 v227, 4294901760, v21
    v_lshlrev_b32 v228, 16, v22
    v_and_b32 v229, 4294901760, v22
    v_lshlrev_b32 v230, 16, v23
    v_and_b32 v231, 4294901760, v23
    v_mul_f32 v224, v224, v80
    v_mul_f32 v225, v225, v81
    v_mul_f32 v226, v226, v82
    v_mul_f32 v227, v227, v83
    v_mul_f32 v228, v228, v84
    v_mul_f32 v229, v229, v85
    v_mul_f32 v230, v230, v86
    v_mul_f32 v231, v231, v87
    v_cvt_pk_bf16_f32 v36, v224, v225
    v_cvt_pk_bf16_f32 v37, v226, v227
    v_cvt_pk_bf16_f32 v38, v228, v229
    v_cvt_pk_bf16_f32 v39, v230, v231
    buffer_store_dwordx4 v[36:39], v2, s[40:43], s48 offen sc1
    s_nop 0
    v_mfma_f32_32x32x16_bf16 v[160:175], v[240:243], v[36:39], 0
    s_waitcnt lgkmcnt(4)
    v_mfma_f32_32x32x16_bf16 v[112:127], v[88:91], v[24:27], 0
    v_lshlrev_b32 v232, 16, v24
    v_and_b32 v233, 4294901760, v24
    v_lshlrev_b32 v234, 16, v25
    v_and_b32 v235, 4294901760, v25
    v_lshlrev_b32 v236, 16, v26
    v_and_b32 v237, 4294901760, v26
    v_lshlrev_b32 v238, 16, v27
    v_and_b32 v239, 4294901760, v27
    v_mul_f32 v232, v232, v80
    v_mul_f32 v233, v233, v81
    v_mul_f32 v234, v234, v82
    v_mul_f32 v235, v235, v83
    v_mul_f32 v236, v236, v84
    v_mul_f32 v237, v237, v85
    v_mul_f32 v238, v238, v86
    v_mul_f32 v239, v239, v87
    v_cvt_pk_bf16_f32 v40, v232, v233
    v_cvt_pk_bf16_f32 v41, v234, v235
    v_cvt_pk_bf16_f32 v42, v236, v237
    v_cvt_pk_bf16_f32 v43, v238, v239
    buffer_store_dwordx4 v[40:43], v2, s[40:43], s49 offen sc1
    s_nop 0
    v_mfma_f32_32x32x16_bf16 v[176:191], v[240:243], v[40:43], 0
    s_waitcnt lgkmcnt(2)
    v_mfma_f32_32x32x16_bf16 v[128:143], v[88:91], v[28:31], 0
    v_lshlrev_b32 v224, 16, v28
    v_and_b32 v225, 4294901760, v28
    v_lshlrev_b32 v226, 16, v29
    v_and_b32 v227, 4294901760, v29
    v_lshlrev_b32 v228, 16, v30
    v_and_b32 v229, 4294901760, v30
    v_lshlrev_b32 v230, 16, v31
    v_and_b32 v231, 4294901760, v31
    v_mul_f32 v224, v224, v80
    v_mul_f32 v225, v225, v81
    v_mul_f32 v226, v226, v82
    v_mul_f32 v227, v227, v83
    v_mul_f32 v228, v228, v84
    v_mul_f32 v229, v229, v85
    v_mul_f32 v230, v230, v86
    v_mul_f32 v231, v231, v87
    v_cvt_pk_bf16_f32 v44, v224, v225
    v_cvt_pk_bf16_f32 v45, v226, v227
    v_cvt_pk_bf16_f32 v46, v228, v229
    v_cvt_pk_bf16_f32 v47, v230, v231
    buffer_store_dwordx4 v[44:47], v2, s[40:43], s50 offen sc1
    s_nop 0
    v_mfma_f32_32x32x16_bf16 v[192:207], v[240:243], v[44:47], 0
    s_waitcnt lgkmcnt(0)
    v_mfma_f32_32x32x16_bf16 v[144:159], v[88:91], v[32:35], 0
    v_lshlrev_b32 v232, 16, v32
    v_and_b32 v233, 4294901760, v32
    v_lshlrev_b32 v234, 16, v33
    v_and_b32 v235, 4294901760, v33
    v_lshlrev_b32 v236, 16, v34
    v_and_b32 v237, 4294901760, v34
    v_lshlrev_b32 v238, 16, v35
    v_and_b32 v239, 4294901760, v35
    v_mul_f32 v232, v232, v80
    v_mul_f32 v233, v233, v81
    v_mul_f32 v234, v234, v82
    v_mul_f32 v235, v235, v83
    v_mul_f32 v236, v236, v84
    v_mul_f32 v237, v237, v85
    v_mul_f32 v238, v238, v86
    v_mul_f32 v239, v239, v87
    v_cvt_pk_bf16_f32 v48, v232, v233
    v_cvt_pk_bf16_f32 v49, v234, v235
    v_cvt_pk_bf16_f32 v50, v236, v237
    v_cvt_pk_bf16_f32 v51, v238, v239
    buffer_store_dwordx4 v[48:51], v2, s[40:43], s51 offen sc1
    s_nop 0
    v_mfma_f32_32x32x16_bf16 v[208:223], v[240:243], v[48:51], 0
    v_cndmask_b32 v244, v96, v160, vcc
    buffer_store_dword v244, v8, s[40:43], s62 offen offset:0
    v_cndmask_b32 v245, v112, v176, vcc
    buffer_store_dword v245, v8, s[40:43], s62 offen offset:128
    v_cndmask_b32 v246, v128, v192, vcc
    buffer_store_dword v246, v8, s[40:43], s62 offen offset:256
    s_nop 5
    v_cndmask_b32 v247, v144, v208, vcc
    buffer_store_dword v247, v8, s[40:43], s62 offen offset:384
    s_nop 1
L_k2_sw1:
L_end_k2_attn_kernel:
    s_endpgm

.globl k3_wo_kernel
.p2align 8
.type k3_wo_kernel,@function
k3_wo_kernel:
    s_cmp_ge_u32 s2, 256
    s_cbranch_scc1 L_end_k3_wo_kernel
    s_load_dwordx16 s[16:31], s[0:1], 0
    s_load_dwordx8 s[32:39], s[0:1], 64
    v_and_b32 v1, 63, v0
    v_lshrrev_b32 v2, 6, v0
    s_nop 0
    v_readfirstlane_b32 s3, v2
    s_bfe_u32 s4, s2, 131073
    s_lshl_b32 s4, s4, 3
    s_bfe_u32 s5, s2, 196611
    s_add_u32 s4, s4, s5
    s_and_b32 s5, s2, 1
    s_lshl_b32 s5, s5, 2
    s_lshr_b32 s62, s2, 6
    s_add_u32 s5, s5, s62
    v_lshlrev_b32 v2, 4, v1
    v_lshrrev_b32 v3, 5, v1
    v_and_b32 v4, 31, v1
    s_lshr_b32 s6, s2, 3
    s_mul_i32 s6, s6, 0
    s_lshr_b32 s6, s6, 5
    s_mul_i32 s61, s3, 8
    s_add_u32 s6, s6, s61
    s_cmp_ge_u32 s6, 32
    s_cselect_b32 s61, 32, 0
    s_sub_u32 s6, s6, s61
    s_lshl_b32 s6, s6, 10
    s_and_b32 s11, s3, 1
    s_lshr_b32 s12, s3, 1
    s_lshl_b32 s13, s4, 1
    s_add_u32 s13, s13, s12
    s_lshl_b32 s14, s5, 1
    s_add_u32 s14, s14, s11
    s_mul_i32 s7, s13, 32768
    s_add_u32 s7, s7, 19922944
    s_xor_b32 s8, s13, 1
    s_mul_i32 s8, s8, 32768
    s_add_u32 s8, s8, 19922944
    s_mul_i32 s9, s14, 32768
    s_add_u32 s9, s9, 16777216
    s_xor_b32 s10, s14, 1
    s_mul_i32 s10, s10, 32768
    s_add_u32 s10, s10, 16777216
    s_waitcnt lgkmcnt(0)
    s_mov_b32 s40, s38
    s_mov_b32 s41, s39
    s_mov_b32 s42, 34603008
    s_mov_b32 s43, 131072
    v_add_u32 v12, s6, v2
    s_add_u32 s6, s6, 1024
    s_cmp_eq_u32 s6, 32768
    s_cselect_b32 s6, 0, s6
    buffer_load_dwordx4 v[104:107], v12, s[40:43], s9 offen
    buffer_load_dwordx4 v[108:111], v12, s[40:43], s7 offen
    buffer_load_dwordx4 v[112:115], v12, s[40:43], s10 offen
    buffer_load_dwordx4 v[116:119], v12, s[40:43], s8 offen
    v_add_u32 v11, s6, v2
    s_add_u32 s6, s6, 1024
    s_cmp_eq_u32 s6, 32768
    s_cselect_b32 s6, 0, s6
    buffer_load_dwordx4 v[120:123], v11, s[40:43], s9 offen
    buffer_load_dwordx4 v[124:127], v11, s[40:43], s7 offen
    buffer_load_dwordx4 v[128:131], v11, s[40:43], s10 offen
    buffer_load_dwordx4 v[132:135], v11, s[40:43], s8 offen
    v_add_u32 v12, s6, v2
    s_add_u32 s6, s6, 1024
    s_cmp_eq_u32 s6, 32768
    s_cselect_b32 s6, 0, s6
    buffer_load_dwordx4 v[136:139], v12, s[40:43], s9 offen
    buffer_load_dwordx4 v[140:143], v12, s[40:43], s7 offen
    buffer_load_dwordx4 v[144:147], v12, s[40:43], s10 offen
    buffer_load_dwordx4 v[148:151], v12, s[40:43], s8 offen
    v_add_u32 v11, s6, v2
    s_add_u32 s6, s6, 1024
    s_cmp_eq_u32 s6, 32768
    s_cselect_b32 s6, 0, s6
    buffer_load_dwordx4 v[152:155], v11, s[40:43], s9 offen
    buffer_load_dwordx4 v[156:159], v11, s[40:43], s7 offen
    buffer_load_dwordx4 v[160:163], v11, s[40:43], s10 offen
    buffer_load_dwordx4 v[164:167], v11, s[40:43], s8 offen
    v_add_u32 v12, s6, v2
    s_add_u32 s6, s6, 1024
    s_cmp_eq_u32 s6, 32768
    s_cselect_b32 s6, 0, s6
    buffer_load_dwordx4 v[168:171], v12, s[40:43], s9 offen
    buffer_load_dwordx4 v[172:175], v12, s[40:43], s7 offen
    buffer_load_dwordx4 v[176:179], v12, s[40:43], s10 offen
    buffer_load_dwordx4 v[180:183], v12, s[40:43], s8 offen
    v_add_u32 v11, s6, v2
    s_add_u32 s6, s6, 1024
    s_cmp_eq_u32 s6, 32768
    s_cselect_b32 s6, 0, s6
    buffer_load_dwordx4 v[184:187], v11, s[40:43], s9 offen
    buffer_load_dwordx4 v[188:191], v11, s[40:43], s7 offen
    buffer_load_dwordx4 v[192:195], v11, s[40:43], s10 offen
    buffer_load_dwordx4 v[196:199], v11, s[40:43], s8 offen
    s_waitcnt vmcnt(20)
    v_mfma_f32_32x32x16_bf16 v[32:47], v[104:107], v[116:119], 0
    v_mfma_f32_32x32x16_bf16 v[48:63], v[112:115], v[108:111], 0
    v_mfma_f32_32x32x16_bf16 v[64:79], v[112:115], v[116:119], 0
    v_mfma_f32_32x32x16_bf16 v[16:31], v[104:107], v[108:111], 0
    v_add_u32 v12, s6, v2
    s_add_u32 s6, s6, 1024
    s_cmp_eq_u32 s6, 32768
    s_cselect_b32 s6, 0, s6
    buffer_load_dwordx4 v[200:203], v12, s[40:43], s9 offen
    buffer_load_dwordx4 v[204:207], v12, s[40:43], s7 offen
    buffer_load_dwordx4 v[208:211], v12, s[40:43], s10 offen
    buffer_load_dwordx4 v[212:215], v12, s[40:43], s8 offen
    v_add_u32 v11, s6, v2
    s_add_u32 s6, s6, 1024
    s_cmp_eq_u32 s6, 32768
    s_cselect_b32 s6, 0, s6
    buffer_load_dwordx4 v[216:219], v11, s[40:43], s9 offen
    buffer_load_dwordx4 v[220:223], v11, s[40:43], s7 offen
    buffer_load_dwordx4 v[224:227], v11, s[40:43], s10 offen
    buffer_load_dwordx4 v[228:231], v11, s[40:43], s8 offen
    s_lshl_b32 s15, s14, 7
    s_add_u32 s15, s15, 10092544
    v_lshlrev_b32 v5, 5, v3
    buffer_load_dwordx4 v[80:83], v5, s[40:43], s15 offen offset:0
    buffer_load_dwordx4 v[84:87], v5, s[40:43], s15 offen offset:16
    buffer_load_dwordx4 v[88:91], v5, s[40:43], s15 offen offset:64
    buffer_load_dwordx4 v[92:95], v5, s[40:43], s15 offen offset:80
    s_mov_b32 s44, s16
    s_mov_b32 s45, s17
    s_mov_b32 s46, 2097152
    s_mov_b32 s47, 131072
    s_lshl_b32 s15, s13, 15
    s_lshl_b32 s60, s14, 6
    s_add_u32 s15, s15, s60
    v_lshlrev_b32 v6, 10, v4
    v_lshl_add_u32 v6, v3, 4, v6
    buffer_load_dwordx4 v[96:99], v6, s[44:47], s15 offen offset:0
    buffer_load_dwordx4 v[100:103], v6, s[44:47], s15 offen offset:32
    v_mul_u32_u24 v8, 14336, v3
    v_lshl_add_u32 v8, v4, 2, v8
    s_min_u32 s15, s2, 111
    s_lshl_b32 s15, s15, 7
    s_mul_i32 s60, s3, 229376
    s_add_u32 s15, s15, s60
    s_add_u32 s15, s15, 11534336
    s_add_u32 s60, s15, 0
    buffer_load_dword v232, v8, s[40:43], s60 offen
    s_add_u32 s60, s15, 28672
    buffer_load_dword v233, v8, s[40:43], s60 offen
    s_add_u32 s60, s15, 57344
    buffer_load_dword v234, v8, s[40:43], s60 offen
    s_add_u32 s60, s15, 86016
    buffer_load_dword v235, v8, s[40:43], s60 offen
    s_add_u32 s60, s15, 114688
    buffer_load_dword v236, v8, s[40:43], s60 offen
    s_add_u32 s60, s15, 143360
    buffer_load_dword v237, v8, s[40:43], s60 offen
    s_add_u32 s60, s15, 172032
    buffer_load_dword v238, v8, s[40:43], s60 offen
    s_add_u32 s60, s15, 200704
    buffer_load_dword v239, v8, s[40:43], s60 offen
    s_getpc_b64 s[48:49]
L_pc_k3_wo_kernel:
    s_lshr_b32 s50, s2, 3
    s_mul_i32 s50, s50, 4
    s_add_u32 s50, s50, s3
    s_lshl_b32 s50, s50, 13
    v_lshlrev_b32 v13, 7, v1
    v_add_u32 v13, s50, v13
    v_min_u32 v13, k5_down_kernel-k4_ffn1_kernel-4, v13
    v_add_u32 v13, k4_ffn1_kernel-L_pc_k3_wo_kernel, v13
    global_load_dword v14, v13, s[48:49]
    s_waitcnt vmcnt(39)
    v_mfma_f32_32x32x16_bf16 v[32:47], v[120:123], v[132:135], v[32:47]
    v_mfma_f32_32x32x16_bf16 v[48:63], v[128:131], v[124:127], v[48:63]
    v_mfma_f32_32x32x16_bf16 v[64:79], v[128:131], v[132:135], v[64:79]
    v_mfma_f32_32x32x16_bf16 v[16:31], v[120:123], v[124:127], v[16:31]
    s_waitcnt vmcnt(35)
    v_mfma_f32_32x32x16_bf16 v[32:47], v[136:139], v[148:151], v[32:47]
    v_mfma_f32_32x32x16_bf16 v[48:63], v[144:147], v[140:143], v[48:63]
    v_mfma_f32_32x32x16_bf16 v[64:79], v[144:147], v[148:151], v[64:79]
    v_mfma_f32_32x32x16_bf16 v[16:31], v[136:139], v[140:143], v[16:31]
    s_waitcnt vmcnt(31)
    v_mfma_f32_32x32x16_bf16 v[32:47], v[152:155], v[164:167], v[32:47]
    v_mfma_f32_32x32x16_bf16 v[48:63], v[160:163], v[156:159], v[48:63]
    v_mfma_f32_32x32x16_bf16 v[64:79], v[160:163], v[164:167], v[64:79]
    v_mfma_f32_32x32x16_bf16 v[16:31], v[152:155], v[156:159], v[16:31]
    s_waitcnt vmcnt(27)
    v_mfma_f32_32x32x16_bf16 v[32:47], v[168:171], v[180:183], v[32:47]
    v_mfma_f32_32x32x16_bf16 v[48:63], v[176:179], v[172:175], v[48:63]
    v_mfma_f32_32x32x16_bf16 v[64:79], v[176:179], v[180:183], v[64:79]
    v_mfma_f32_32x32x16_bf16 v[16:31], v[168:171], v[172:175], v[16:31]
    s_waitcnt vmcnt(23)
    v_mfma_f32_32x32x16_bf16 v[32:47], v[184:187], v[196:199], v[32:47]
    v_mfma_f32_32x32x16_bf16 v[48:63], v[192:195], v[188:191], v[48:63]
    v_mfma_f32_32x32x16_bf16 v[64:79], v[192:195], v[196:199], v[64:79]
    v_mfma_f32_32x32x16_bf16 v[16:31], v[184:187], v[188:191], v[16:31]
    s_waitcnt vmcnt(19)
    v_mfma_f32_32x32x16_bf16 v[32:47], v[200:203], v[212:215], v[32:47]
    v_mfma_f32_32x32x16_bf16 v[48:63], v[208:211], v[204:207], v[48:63]
    v_mfma_f32_32x32x16_bf16 v[64:79], v[208:211], v[212:215], v[64:79]
    v_mfma_f32_32x32x16_bf16 v[16:31], v[200:203], v[204:207], v[16:31]
    s_waitcnt vmcnt(15)
    v_mfma_f32_32x32x16_bf16 v[32:47], v[216:219], v[228:231], v[32:47]
    v_mfma_f32_32x32x16_bf16 v[48:63], v[224:227], v[220:223], v[48:63]
    v_mfma_f32_32x32x16_bf16 v[64:79], v[224:227], v[228:231], v[64:79]
    v_mfma_f32_32x32x16_bf16 v[16:31], v[216:219], v[220:223], v[16:31]
    s_xor_b32 s15, s3, 2
    s_mul_i32 s15, s15, 12288
    v_add_u32 v8, s15, v2
    s_xor_b32 s15, s3, 1
    s_mul_i32 s15, s15, 12288
    v_add_u32 v9, s15, v2
    s_xor_b32 s15, s3, 3
    s_mul_i32 s15, s15, 12288
    v_add_u32 v10, s15, v2
    ds_write_b128 v8, v[32:35] offset:0
    ds_write_b128 v8, v[36:39] offset:1024
    ds_write_b128 v8, v[40:43] offset:2048
    ds_write_b128 v8, v[44:47] offset:3072
    ds_write_b128 v9, v[48:51] offset:4096
    ds_write_b128 v9, v[52:55] offset:5120
    ds_write_b128 v9, v[56:59] offset:6144
    ds_write_b128 v9, v[60:63] offset:7168
    ds_write_b128 v10, v[64:67] offset:8192
    ds_write_b128 v10, v[68:71] offset:9216
    ds_write_b128 v10, v[72:75] offset:10240
    ds_write_b128 v10, v[76:79] offset:11264
    s_mul_i32 s15, s3, 12288
    v_add_u32 v7, s15, v2
    s_waitcnt vmcnt(1)
    v_add_f32 v232, v232, v236
    v_add_f32 v233, v233, v237
    v_add_f32 v234, v234, v238
    v_add_f32 v235, v235, v239
    v_add_f32 v232, v232, v234
    v_add_f32 v233, v233, v235
    v_add_f32 v232, v232, v233
    v_lshlrev_b32 v15, 2, v0
    ds_write_b32 v15, v232 offset:49152
    s_waitcnt lgkmcnt(0)
    s_barrier
    ds_read_b128 v[32:35], v7 offset:0
    ds_read_b128 v[36:39], v7 offset:1024
    ds_read_b128 v[40:43], v7 offset:2048
    ds_read_b128 v[44:47], v7 offset:3072
    ds_read_b128 v[48:51], v7 offset:4096
    ds_read_b128 v[52:55], v7 offset:5120
    ds_read_b128 v[56:59], v7 offset:6144
    ds_read_b128 v[60:63], v7 offset:7168
    ds_read_b128 v[64:67], v7 offset:8192
    ds_read_b128 v[68:71], v7 offset:9216
    ds_read_b128 v[72:75], v7 offset:10240
    ds_read_b128 v[76:79], v7 offset:11264
    s_waitcnt lgkmcnt(8)
    v_add_f32 v16, v16, v32
    v_add_f32 v17, v17, v33
    v_add_f32 v18, v18, v34
    v_add_f32 v19, v19, v35
    v_add_f32 v20, v20, v36
    v_add_f32 v21, v21, v37
    v_add_f32 v22, v22, v38
    v_add_f32 v23, v23, v39
    v_add_f32 v24, v24, v40
    v_add_f32 v25, v25, v41
    v_add_f32 v26, v26, v42
    v_add_f32 v27, v27, v43
    v_add_f32 v28, v28, v44
    v_add_f32 v29, v29, v45
    v_add_f32 v30, v30, v46
    v_add_f32 v31, v31, v47
    s_waitcnt lgkmcnt(4)
    v_add_f32 v16, v16, v48
    v_add_f32 v17, v17, v49
    v_add_f32 v18, v18, v50
    v_add_f32 v19, v19, v51
    v_add_f32 v20, v20, v52
    v_add_f32 v21, v21, v53
    v_add_f32 v22, v22, v54
    v_add_f32 v23, v23, v55
    v_add_f32 v24, v24, v56
    v_add_f32 v25, v25, v57
    v_add_f32 v26, v26, v58
    v_add_f32 v27, v27, v59
    v_add_f32 v28, v28, v60
    v_add_f32 v29, v29, v61
    v_add_f32 v30, v30, v62
    v_add_f32 v31, v31, v63
    s_waitcnt lgkmcnt(0)
    v_add_f32 v16, v16, v64
    v_add_f32 v17, v17, v65
    v_add_f32 v18, v18, v66
    v_add_f32 v19, v19, v67
    v_add_f32 v20, v20, v68
    v_add_f32 v21, v21, v69
    v_add_f32 v22, v22, v70
    v_add_f32 v23, v23, v71
    v_add_f32 v24, v24, v72
    v_add_f32 v25, v25, v73
    v_add_f32 v26, v26, v74
    v_add_f32 v27, v27, v75
    v_add_f32 v28, v28, v76
    v_add_f32 v29, v29, v77
    v_add_f32 v30, v30, v78
    v_add_f32 v31, v31, v79
    s_waitcnt vmcnt(1)
    v_lshlrev_b32 v48, 16, v96
    v_and_b32 v49, 4294901760, v96
    v_lshlrev_b32 v50, 16, v97
    v_and_b32 v51, 4294901760, v97
    v_lshlrev_b32 v52, 16, v98
    v_and_b32 v53, 4294901760, v98
    v_lshlrev_b32 v54, 16, v99
    v_and_b32 v55, 4294901760, v99
    v_lshlrev_b32 v56, 16, v100
    v_and_b32 v57, 4294901760, v100
    v_lshlrev_b32 v58, 16, v101
    v_and_b32 v59, 4294901760, v101
    v_lshlrev_b32 v60, 16, v102
    v_and_b32 v61, 4294901760, v102
    v_lshlrev_b32 v62, 16, v103
    v_and_b32 v63, 4294901760, v103
    v_fmac_f32 v48, v16, v80
    v_fmac_f32 v49, v17, v81
    v_fmac_f32 v50, v18, v82
    v_fmac_f32 v51, v19, v83
    v_fmac_f32 v52, v20, v84
    v_fmac_f32 v53, v21, v85
    v_fmac_f32 v54, v22, v86
    v_fmac_f32 v55, v23, v87
    v_fmac_f32 v56, v24, v88
    v_fmac_f32 v57, v25, v89
    v_fmac_f32 v58, v26, v90
    v_fmac_f32 v59, v27, v91
    v_fmac_f32 v60, v28, v92
    v_fmac_f32 v61, v29, v93
    v_fmac_f32 v62, v30, v94
    v_fmac_f32 v63, v31, v95
    v_cvt_pk_bf16_f32 v32, v48, v49
    v_cvt_pk_bf16_f32 v33, v50, v51
    v_cvt_pk_bf16_f32 v34, v52, v53
    v_cvt_pk_bf16_f32 v35, v54, v55
    v_cvt_pk_bf16_f32 v36, v56, v57
    v_cvt_pk_bf16_f32 v37, v58, v59
    v_cvt_pk_bf16_f32 v38, v60, v61
    v_cvt_pk_bf16_f32 v39, v62, v63
    s_lshl_b32 s15, s13, 15
    s_lshl_b32 s60, s14, 11
    s_add_u32 s15, s15, s60
    s_add_u32 s15, s15, 22020096
    buffer_store_dwordx4 v[32:35], v2, s[40:43], s15 offen offset:0 sc1
    buffer_store_dwordx4 v[36:39], v2, s[40:43], s15 offen offset:1024 sc1
    v_lshlrev_b32 v48, 16, v32
    v_and_b32 v49, 4294901760, v32
    v_lshlrev_b32 v50, 16, v33
    v_and_b32 v51, 4294901760, v33
    v_lshlrev_b32 v52, 16, v34
    v_and_b32 v53, 4294901760, v34
    v_lshlrev_b32 v54, 16, v35
    v_and_b32 v55, 4294901760, v35
    v_lshlrev_b32 v56, 16, v36
    v_and_b32 v57, 4294901760, v36
    v_lshlrev_b32 v58, 16, v37
    v_and_b32 v59, 4294901760, v37
    v_lshlrev_b32 v60, 16, v38
    v_and_b32 v61, 4294901760, v38
    v_lshlrev_b32 v62, 16, v39
    v_and_b32 v63, 4294901760, v39
    v_add_f32 v8, v48, v49
    v_add_f32 v9, v50, v51
    v_add_f32 v8, v8, v52
    v_add_f32 v9, v9, v53
    v_add_f32 v8, v8, v54
    v_add_f32 v9, v9, v55
    v_add_f32 v8, v8, v56
    v_add_f32 v9, v9, v57
    v_add_f32 v8, v8, v58
    v_add_f32 v9, v9, v59
    v_add_f32 v8, v8, v60
    v_add_f32 v9, v9, v61
    v_add_f32 v8, v8, v62
    v_add_f32 v9, v9, v63
    v_add_f32 v8, v8, v9
    v_mov_b32 v9, v8
    s_nop 1
    v_permlane32_swap_b32 v8, v9
    v_add_f32 v8, v8, v9
    v_mul_f32 v8, 1023410176, v8
    v_sub_f32 v48, v48, v8
    v_sub_f32 v49, v49, v8
    v_sub_f32 v50, v50, v8
    v_sub_f32 v51, v51, v8
    v_sub_f32 v52, v52, v8
    v_sub_f32 v53, v53, v8
    v_sub_f32 v54, v54, v8
    v_sub_f32 v55, v55, v8
    v_sub_f32 v56, v56, v8
    v_sub_f32 v57, v57, v8
    v_sub_f32 v58, v58, v8
    v_sub_f32 v59, v59, v8
    v_sub_f32 v60, v60, v8
    v_sub_f32 v61, v61, v8
    v_sub_f32 v62, v62, v8
    v_sub_f32 v63, v63, v8
    v_mul_f32 v9, v48, v48
    v_mul_f32 v10, v49, v49
    v_fmac_f32 v9, v50, v50
    v_fmac_f32 v10, v51, v51
    v_fmac_f32 v9, v52, v52
    v_fmac_f32 v10, v53, v53
    v_fmac_f32 v9, v54, v54
    v_fmac_f32 v10, v55, v55
    v_fmac_f32 v9, v56, v56
    v_fmac_f32 v10, v57, v57
    v_fmac_f32 v9, v58, v58
    v_fmac_f32 v10, v59, v59
    v_fmac_f32 v9, v60, v60
    v_fmac_f32 v10, v61, v61
    v_fmac_f32 v9, v62, v62
    v_fmac_f32 v10, v63, v63
    v_add_f32 v9, v9, v10
    v_mov_b32 v10, v9
    s_nop 1
    v_permlane32_swap_b32 v9, v10
    v_add_f32 v9, v9, v10
    s_lshl_b32 s15, s13, 12
    s_lshl_b32 s60, s5, 9
    s_add_u32 s15, s15, s60
    s_lshl_b32 s60, s11, 3
    s_add_u32 s15, s15, s60
    s_add_u32 s15, s15, 11010048
    v_lshlrev_b32 v10, 4, v4
    s_mov_b32 exec_hi, 0
    buffer_store_dwordx2 v[8:9], v10, s[40:43], s15 offen
    s_mov_b64 exec, -1
    s_cmp_ge_u32 s2, 112
    s_cbranch_scc1 L_k3_wo_kernel_noside
    s_cmp_lg_u32 s3, 0
    s_cbranch_scc1 L_k3_wo_kernel_noside
    v_lshlrev_b32 v15, 2, v1
    ds_read_b32 v120, v15 offset:49152
    ds_read_b32 v121, v15 offset:49408
    ds_read_b32 v122, v15 offset:49664
    ds_read_b32 v123, v15 offset:49920
    s_waitcnt lgkmcnt(0)
    v_add_f32 v120, v120, v122
    v_add_f32 v121, v121, v123
    v_add_f32 v120, v120, v121
    v_cvt_pk_bf16_f32 v32, v120, v120
    v_and_b32 v9, 4294901760, v32
    v_sub_f32 v9, v120, v9
    v_cvt_pk_bf16_f32 v33, v9, v9
    v_mov_b32 v34, 0
    v_mov_b32 v35, 0
    s_mul_i32 s60, s2, 147
    s_lshr_b32 s60, s60, 10
    s_mul_i32 s61, s60, 7
    s_sub_u32 s61, s2, s61
    s_mul_i32 s60, s60, 236544
    s_lshl_b32 s61, s61, 10
    s_add_u32 s60, s60, s61
    s_add_u32 s60, s60, 12812288
    buffer_store_dwordx4 v[32:35], v2, s[40:43], s60 offen
    s_nop 1
L_k3_wo_kernel_noside:
L_end_k3_wo_kernel:
    s_endpgm

.globl k4_ffn1_kernel
.p2align 8
.type k4_ffn1_kernel,@function
k4_ffn1_kernel:
    s_cmp_ge_u32 s2, 256
    s_cbranch_scc1 L_end_k4_ffn1_kernel
    s_load_dwordx8 s[32:39], s[0:1], 64
    v_and_b32 v1, 63, v0
    v_lshrrev_b32 v2, 6, v0
    s_nop 0
    v_readfirstlane_b32 s3, v2
    s_bfe_u32 s4, s2, 131073
    s_lshl_b32 s4, s4, 2
    s_bfe_u32 s5, s2, 131075
    s_add_u32 s4, s4, s5
    s_and_b32 s5, s2, 1
    s_lshl_b32 s5, s5, 3
    s_lshr_b32 s62, s2, 5
    s_add_u32 s5, s5, s62
    s_and_b32 s61, s3, 3
    s_lshr_b32 s63, s3, 2
    s_lshl_b32 s6, s4, 2
    s_add_u32 s6, s6, s61
    v_lshlrev_b32 v2, 4, v1
    v_lshrrev_b32 v3, 5, v1
    v_and_b32 v4, 31, v1
    s_mul_i32 s7, s5, 236544
    s_add_u32 s7, s7, 12582912
    s_lshl_b32 s8, s3, 10
    s_lshl_b32 s9, s6, 15
    s_add_u32 s9, s9, 22020096
    s_and_b32 s10, s3, 1
    s_and_b32 s11, s3, 2
    s_lshl_b32 s11, s11, 1
    s_add_u32 s10, s10, s11
    s_lshl_b32 s10, s10, 10
    s_add_u32 s10, s10, s7
    s_mov_b32 s11, 7168
    s_cmp_eq_u32 s63, 0
    s_cselect_b32 s9, s9, s10
    s_cselect_b32 s11, 1024, s11
    s_mul_i32 s12, s3, 7168
    s_add_u32 s12, s12, s7
    s_lshl_b32 s13, s61, 10
    v_add_u32 v5, s13, v2
    s_lshl_b32 s13, s63, 11
    s_add_u32 s13, s13, 4096
    v_add_u32 v6, s13, v2
    v_add_u32 v7, 131072, v2
    s_xor_b32 s13, s63, 1
    s_lshl_b32 s13, s13, 15
    v_add_u32 v15, s13, v2
    v_add_u32 v0, 65536, v5
    v_add_u32 v1, 65536, v6
    s_waitcnt lgkmcnt(0)
    s_mov_b32 s40, s38
    s_mov_b32 s41, s39
    s_mov_b32 s42, 34603008
    s_mov_b32 s43, 131072
    s_cmp_eq_u32 s63, 0
    s_cbranch_scc0 L_k4_g1
    s_add_u32 m0, s8, 0
    s_nop 0
    buffer_load_dwordx4 v2, s[40:43], s9 offen lds
    s_add_u32 s9, s9, s11
    s_add_u32 m0, s8, 131072
    s_add_u32 s13, s12, 2048
    buffer_load_dwordx4 v2, s[40:43], s13 offen lds
    s_add_u32 m0, s8, 8192
    s_nop 0
    buffer_load_dwordx4 v2, s[40:43], s9 offen lds
    s_add_u32 s9, s9, s11
    s_add_u32 m0, s8, 16384
    s_nop 0
    buffer_load_dwordx4 v2, s[40:43], s9 offen lds
    s_add_u32 s9, s9, s11
    s_add_u32 m0, s8, 24576
    s_nop 0
    buffer_load_dwordx4 v2, s[40:43], s9 offen lds
    s_add_u32 s9, s9, s11
    s_add_u32 m0, s8, 32768
    s_nop 0
    buffer_load_dwordx4 v2, s[40:43], s9 offen lds
    s_add_u32 s9, s9, s11
    s_add_u32 m0, s8, 40960
    s_nop 0
    buffer_load_dwordx4 v2, s[40:43], s9 offen lds
    s_add_u32 s9, s9, s11
    s_add_u32 m0, s8, 49152
    s_nop 0
    buffer_load_dwordx4 v2, s[40:43], s9 offen lds
    s_add_u32 s9, s9, s11
    s_add_u32 m0, s8, 57344
    s_nop 0
    buffer_load_dwordx4 v2, s[40:43], s9 offen lds
    s_add_u32 s9, s9, s11
    s_waitcnt vmcnt(6)
    s_barrier
    ds_read_b128 a[0:3], v5 offset:0
    ds_read_b128 v[80:83], v6 offset:0
    ds_read_b128 v[84:87], v6 offset:1024
    ds_read_b128 v[88:91], v7 offset:0
    ds_read_b128 a[4:7], v5 offset:8192
    ds_read_b128 v[92:95], v6 offset:8192
    ds_read_b128 v[96:99], v6 offset:9216
    ds_read_b128 v[100:103], v7 offset:1024
    s_waitcnt lgkmcnt(4)
    v_mfma_f32_32x32x16_bf16 v[16:31], v[80:83], a[0:3], 0
    s_add_u32 m0, s8, 65536
    s_nop 0
    buffer_load_dwordx4 v2, s[40:43], s9 offen lds
    s_add_u32 s9, s9, s11
    v_mfma_f32_32x32x16_bf16 v[32:47], v[84:87], a[0:3], 0
    s_lshl_b32 s13, s6, 12
    s_add_u32 s13, s13, 11010048
    v_lshlrev_b32 v8, 11, v3
    v_lshl_add_u32 v8, v4, 4, v8
    buffer_load_dwordx4 v[64:67], v8, s[40:43], s13 offen offset:0
    buffer_load_dwordx4 v[68:71], v8, s[40:43], s13 offen offset:512
    buffer_load_dwordx4 v[72:75], v8, s[40:43], s13 offen offset:1024
    buffer_load_dwordx4 v[76:79], v8, s[40:43], s13 offen offset:1536
    v_mfma_f32_32x32x16_bf16 v[48:63], v[88:91], a[0:3], 0
    s_waitcnt vmcnt(9)
    s_barrier
    ds_read_b128 a[8:11], v5 offset:16384
    ds_read_b128 v[80:83], v6 offset:16384
    ds_read_b128 v[84:87], v6 offset:17408
    ds_read_b128 v[88:91], v7 offset:2048
    s_waitcnt lgkmcnt(4)
    v_mfma_f32_32x32x16_bf16 v[16:31], v[92:95], a[4:7], v[16:31]
    s_add_u32 m0, s8, 73728
    s_nop 0
    buffer_load_dwordx4 v2, s[40:43], s9 offen lds
    s_add_u32 s9, s9, s11
    v_mfma_f32_32x32x16_bf16 v[32:47], v[96:99], a[4:7], v[32:47]
    s_add_u32 m0, s8, 139264
    s_add_u32 s13, s12, 59392
    buffer_load_dwordx4 v2, s[40:43], s13 offen lds
    v_mfma_f32_32x32x16_bf16 v[48:63], v[100:103], a[4:7], v[48:63]
    ds_read_b128 a[12:15], v5 offset:24576
    ds_read_b128 v[92:95], v6 offset:24576
    ds_read_b128 v[96:99], v6 offset:25600
    ds_read_b128 v[100:103], v7 offset:3072
    s_waitcnt lgkmcnt(4)
    v_mfma_f32_32x32x16_bf16 v[16:31], v[80:83], a[8:11], v[16:31]
    s_add_u32 m0, s8, 81920
    s_nop 0
    buffer_load_dwordx4 v2, s[40:43], s9 offen lds
    s_add_u32 s9, s9, s11
    v_mfma_f32_32x32x16_bf16 v[32:47], v[84:87], a[8:11], v[32:47]
    v_mfma_f32_32x32x16_bf16 v[48:63], v[88:91], a[8:11], v[48:63]
    s_waitcnt vmcnt(10)
    s_barrier
    ds_read_b128 a[16:19], v5 offset:32768
    ds_read_b128 v[80:83], v6 offset:32768
    ds_read_b128 v[84:87], v6 offset:33792
    ds_read_b128 v[88:91], v7 offset:4096
    s_waitcnt lgkmcnt(4)
    v_mfma_f32_32x32x16_bf16 v[16:31], v[92:95], a[12:15], v[16:31]
    s_add_u32 m0, s8, 90112
    s_nop 0
    buffer_load_dwordx4 v2, s[40:43], s9 offen lds
    s_add_u32 s9, s9, s11
    v_mfma_f32_32x32x16_bf16 v[32:47], v[96:99], a[12:15], v[32:47]
    v_mfma_f32_32x32x16_bf16 v[48:63], v[100:103], a[12:15], v[48:63]
    ds_read_b128 a[20:23], v5 offset:40960
    ds_read_b128 v[92:95], v6 offset:40960
    ds_read_b128 v[96:99], v6 offset:41984
    ds_read_b128 v[100:103], v7 offset:5120
    s_waitcnt lgkmcnt(4)
    v_mfma_f32_32x32x16_bf16 v[16:31], v[80:83], a[16:19], v[16:31]
    s_add_u32 m0, s8, 98304
    s_nop 0
    buffer_load_dwordx4 v2, s[40:43], s9 offen lds
    s_add_u32 s9, s9, s11
    v_mfma_f32_32x32x16_bf16 v[32:47], v[84:87], a[16:19], v[32:47]
    v_mfma_f32_32x32x16_bf16 v[48:63], v[88:91], a[16:19], v[48:63]
    s_waitcnt vmcnt(10)
    s_barrier
    ds_read_b128 a[24:27], v5 offset:49152
    ds_read_b128 v[80:83], v6 offset:49152
    ds_read_b128 v[84:87], v6 offset:50176
    ds_read_b128 v[88:91], v7 offset:6144
    s_waitcnt lgkmcnt(4)
    v_mfma_f32_32x32x16_bf16 v[16:31], v[92:95], a[20:23], v[16:31]
    s_add_u32 m0, s8, 106496
    s_nop 0
    buffer_load_dwordx4 v2, s[40:43], s9 offen lds
    s_add_u32 s9, s9, s11
    v_mfma_f32_32x32x16_bf16 v[32:47], v[96:99], a[20:23], v[32:47]
    s_add_u32 m0, s8, 147456
    s_add_u32 s13, s12, 116736
    buffer_load_dwordx4 v2, s[40:43], s13 offen lds
    v_mfma_f32_32x32x16_bf16 v[48:63], v[100:103], a[20:23], v[48:63]
    ds_read_b128 a[28:31], v5 offset:57344
    ds_read_b128 v[92:95], v6 offset:57344
    ds_read_b128 v[96:99], v6 offset:58368
    ds_read_b128 v[100:103], v7 offset:7168
    s_waitcnt lgkmcnt(4)
    v_mfma_f32_32x32x16_bf16 v[16:31], v[80:83], a[24:27], v[16:31]
    s_add_u32 m0, s8, 114688
    s_nop 0
    buffer_load_dwordx4 v2, s[40:43], s9 offen lds
    s_add_u32 s9, s9, s11
    v_mfma_f32_32x32x16_bf16 v[32:47], v[84:87], a[24:27], v[32:47]
    v_mfma_f32_32x32x16_bf16 v[48:63], v[88:91], a[24:27], v[48:63]
    s_waitcnt vmcnt(6)
    s_barrier
    ds_read_b128 a[32:35], v0 offset:0
    ds_read_b128 v[80:83], v1 offset:0
    ds_read_b128 v[84:87], v1 offset:1024
    ds_read_b128 v[88:91], v7 offset:8192
    s_waitcnt lgkmcnt(4)
    v_mfma_f32_32x32x16_bf16 v[16:31], v[92:95], a[28:31], v[16:31]
    s_add_u32 m0, s8, 122880
    s_nop 0
    buffer_load_dwordx4 v2, s[40:43], s9 offen lds
    s_add_u32 s9, s9, s11
    v_mfma_f32_32x32x16_bf16 v[32:47], v[96:99], a[28:31], v[32:47]
    v_mfma_f32_32x32x16_bf16 v[48:63], v[100:103], a[28:31], v[48:63]
    ds_read_b128 a[36:39], v0 offset:8192
    ds_read_b128 v[92:95], v1 offset:8192
    ds_read_b128 v[96:99], v1 offset:9216
    ds_read_b128 v[100:103], v7 offset:9216
    s_waitcnt lgkmcnt(4)
    v_mfma_f32_32x32x16_bf16 v[16:31], v[80:83], a[32:35], v[16:31]
    s_add_u32 m0, s8, 0
    s_nop 0
    buffer_load_dwordx4 v2, s[40:43], s9 offen lds
    s_add_u32 s9, s9, s11
    v_mfma_f32_32x32x16_bf16 v[32:47], v[84:87], a[32:35], v[32:47]
    v_mfma_f32_32x32x16_bf16 v[48:63], v[88:91], a[32:35], v[48:63]
    s_waitcnt vmcnt(6)
    s_barrier
    ds_read_b128 a[40:43], v0 offset:16384
    ds_read_b128 v[80:83], v1 offset:16384
    ds_read_b128 v[84:87], v1 offset:17408
    ds_read_b128 v[88:91], v7 offset:10240
    s_waitcnt lgkmcnt(4)
    v_mfma_f32_32x32x16_bf16 v[16:31], v[92:95], a[36:39], v[16:31]
    s_add_u32 m0, s8, 8192
    s_nop 0
    buffer_load_dwordx4 v2, s[40:43], s9 offen lds
    s_add_u32 s9, s9, s11
    v_mfma_f32_32x32x16_bf16 v[32:47], v[96:99], a[36:39], v[32:47]
    v_mfma_f32_32x32x16_bf16 v[48:63], v[100:103], a[36:39], v[48:63]
    ds_read_b128 a[44:47], v0 offset:24576
    ds_read_b128 v[92:95], v1 offset:24576
    ds_read_b128 v[96:99], v1 offset:25600
    ds_read_b128 v[100:103], v7 offset:11264
    s_waitcnt lgkmcnt(4)
    v_mfma_f32_32x32x16_bf16 v[16:31], v[80:83], a[40:43], v[16:31]
    s_add_u32 m0, s8, 16384
    s_nop 0
    buffer_load_dwordx4 v2, s[40:43], s9 offen lds
    s_add_u32 s9, s9, s11
    v_mfma_f32_32x32x16_bf16 v[32:47], v[84:87], a[40:43], v[32:47]
    s_add_u32 m0, s8, 155648
    s_add_u32 s13, s12, 174080
    buffer_load_dwordx4 v2, s[40:43], s13 offen lds
    v_mfma_f32_32x32x16_bf16 v[48:63], v[88:91], a[40:43], v[48:63]
    s_waitcnt vmcnt(7)
    s_barrier
    ds_read_b128 a[48:51], v0 offset:32768
    ds_read_b128 v[80:83], v1 offset:32768
    ds_read_b128 v[84:87], v1 offset:33792
    ds_read_b128 v[88:91], v7 offset:12288
    s_waitcnt lgkmcnt(4)
    v_mfma_f32_32x32x16_bf16 v[16:31], v[92:95], a[44:47], v[16:31]
    s_add_u32 m0, s8, 24576
    s_nop 0
    buffer_load_dwordx4 v2, s[40:43], s9 offen lds
    s_add_u32 s9, s9, s11
    v_add_f32 v8, v64, v66
    v_add_f32 v8, v8, v68
    v_add_f32 v8, v8, v70
    v_add_f32 v8, v8, v72
    v_mfma_f32_32x32x16_bf16 v[32:47], v[96:99], a[44:47], v[32:47]
    v_add_f32 v8, v8, v74
    v_add_f32 v8, v8, v76
    v_add_f32 v8, v8, v78
    v_mov_b32 v9, v8
    v_mfma_f32_32x32x16_bf16 v[48:63], v[100:103], a[44:47], v[48:63]
    s_nop 0
    v_permlane32_swap_b32 v8, v9
    v_add_f32 v8, v8, v9
    v_mul_f32 v8, 1031798784, v8
    v_add_f32 v9, v65, v67
    ds_read_b128 a[52:55], v0 offset:40960
    ds_read_b128 v[92:95], v1 offset:40960
    ds_read_b128 v[96:99], v1 offset:41984
    ds_read_b128 v[100:103], v7 offset:13312
    s_waitcnt lgkmcnt(4)
    v_mfma_f32_32x32x16_bf16 v[16:31], v[80:83], a[48:51], v[16:31]
    s_add_u32 m0, s8, 32768
    s_nop 0
    buffer_load_dwordx4 v2, s[40:43], s9 offen lds
    s_add_u32 s9, s9, s11
    v_add_f32 v9, v9, v69
    v_add_f32 v9, v9, v71
    v_add_f32 v9, v9, v73
    v_add_f32 v9, v9, v75
    v_mfma_f32_32x32x16_bf16 v[32:47], v[84:87], a[48:51], v[32:47]
    v_add_f32 v9, v9, v77
    v_add_f32 v9, v9, v79
    v_mov_b32 v10, 0
    v_sub_f32 v64, v64, v8
    v_mfma_f32_32x32x16_bf16 v[48:63], v[88:91], a[48:51], v[48:63]
    v_fmac_f32 v10, v64, v64
    v_sub_f32 v66, v66, v8
    v_fmac_f32 v10, v66, v66
    v_sub_f32 v68, v68, v8
    s_waitcnt vmcnt(6)
    s_barrier
    ds_read_b128 a[56:59], v0 offset:49152
    ds_read_b128 v[80:83], v1 offset:49152
    ds_read_b128 v[84:87], v1 offset:50176
    ds_read_b128 v[88:91], v7 offset:14336
    s_waitcnt lgkmcnt(4)
    v_mfma_f32_32x32x16_bf16 v[16:31], v[92:95], a[52:55], v[16:31]
    s_add_u32 m0, s8, 40960
    s_nop 0
    buffer_load_dwordx4 v2, s[40:43], s9 offen lds
    s_add_u32 s9, s9, s11
    v_fmac_f32 v10, v68, v68
    v_sub_f32 v70, v70, v8
    v_fmac_f32 v10, v70, v70
    v_sub_f32 v72, v72, v8
    v_mfma_f32_32x32x16_bf16 v[32:47], v[96:99], a[52:55], v[32:47]
    v_fmac_f32 v10, v72, v72
    v_sub_f32 v74, v74, v8
    v_fmac_f32 v10, v74, v74
    v_sub_f32 v76, v76, v8
    v_mfma_f32_32x32x16_bf16 v[48:63], v[100:103], a[52:55], v[48:63]
    v_fmac_f32 v10, v76, v76
    v_sub_f32 v78, v78, v8
    v_fmac_f32 v10, v78, v78
    v_fmac_f32 v9, 1107296256, v10
    ds_read_b128 a[60:63], v0 offset:57344
    ds_read_b128 v[92:95], v1 offset:57344
    ds_read_b128 v[96:99], v1 offset:58368
    ds_read_b128 v[100:103], v7 offset:15360
    s_waitcnt lgkmcnt(4)
    v_mfma_f32_32x32x16_bf16 v[16:31], v[80:83], a[56:59], v[16:31]
    s_add_u32 m0, s8, 49152
    s_nop 0
    buffer_load_dwordx4 v2, s[40:43], s9 offen lds
    s_add_u32 s9, s9, s11
    v_mov_b32 v10, v9
    s_nop 1
    v_permlane32_swap_b32 v9, v10
    v_add_f32 v9, v9, v10
    v_mov_b32 v10, 925353388
    v_mfma_f32_32x32x16_bf16 v[32:47], v[84:87], a[56:59], v[32:47]
    v_fmac_f32 v10, 989855744, v9
    v_rsq_f32 v11, v10
    s_nop 0
    v_mul_f32 v12, v10, v11
    v_sub_f32 v13, 0, v8
    v_mfma_f32_32x32x16_bf16 v[48:63], v[88:91], a[56:59], v[48:63]
    v_cmp_eq_u32 vcc, 0, v3
    s_nop 1
    v_cndmask_b32 v13, v12, v13, vcc
    v_cvt_pk_bf16_f32 v14, v13, v13
    v_and_b32 v14, 4294901760, v14
    s_waitcnt vmcnt(6)
    s_barrier
    ds_read_b128 a[64:67], v5 offset:0
    ds_read_b128 v[80:83], v6 offset:0
    ds_read_b128 v[84:87], v6 offset:1024
    ds_read_b128 v[88:91], v7 offset:16384
    s_waitcnt lgkmcnt(4)
    v_mfma_f32_32x32x16_bf16 v[16:31], v[92:95], a[60:63], v[16:31]
    s_add_u32 m0, s8, 57344
    s_nop 0
    buffer_load_dwordx4 v2, s[40:43], s9 offen lds
    s_add_u32 s9, s9, s11
    v_sub_f32 v9, v13, v14
    v_cvt_pk_bf16_f32 v104, v14, v9
    v_mov_b32 v105, v104
    v_mov_b32 v106, 0
    v_mfma_f32_32x32x16_bf16 v[32:47], v[96:99], a[60:63], v[32:47]
    v_mov_b32 v107, 0
    v_mul_f32 v12, 3222493025, v11
    v_mul_f32 v13, v11, v11
    v_mul_f32 v13, v13, v11
    v_mfma_f32_32x32x16_bf16 v[48:63], v[100:103], a[60:63], v[48:63]
    v_mul_f32 v13, 3184710632, v13
    s_mul_i32 s60, s6, 114688
    s_mul_i32 s62, s5, 7168
    s_add_u32 s60, s60, s62
    ds_read_b128 a[68:71], v5 offset:8192
    ds_read_b128 v[92:95], v6 offset:8192
    ds_read_b128 v[96:99], v6 offset:9216
    ds_read_b128 v[100:103], v7 offset:17408
    s_waitcnt lgkmcnt(4)
    v_mfma_f32_32x32x16_bf16 v[16:31], v[80:83], a[64:67], v[16:31]
    s_add_u32 m0, s8, 65536
    s_nop 0
    buffer_load_dwordx4 v2, s[40:43], s9 offen lds
    s_add_u32 s9, s9, s11
    s_add_u32 s60, s60, 25165824
    v_mfma_f32_32x32x16_bf16 v[32:47], v[84:87], a[64:67], v[32:47]
    s_add_u32 s13, s7, 229376
    s_add_u32 s14, s13, 0
    buffer_load_dwordx4 v[108:111], v2, s[40:43], s14 offen
    s_add_u32 s14, s13, 1024
    buffer_load_dwordx4 v[112:115], v2, s[40:43], s14 offen
    s_add_u32 s14, s13, 2048
    buffer_load_dwordx4 v[116:119], v2, s[40:43], s14 offen
    s_add_u32 s14, s13, 3072
    buffer_load_dwordx4 v[124:127], v2, s[40:43], s14 offen
    v_mfma_f32_32x32x16_bf16 v[48:63], v[88:91], a[64:67], v[48:63]
    s_waitcnt vmcnt(9)
    s_barrier
    ds_read_b128 a[72:75], v5 offset:16384
    ds_read_b128 v[80:83], v6 offset:16384
    ds_read_b128 v[84:87], v6 offset:17408
    ds_read_b128 v[88:91], v7 offset:18432
    s_waitcnt lgkmcnt(4)
    v_mfma_f32_32x32x16_bf16 v[16:31], v[92:95], a[68:71], v[16:31]
    s_add_u32 m0, s8, 73728
    s_nop 0
    buffer_load_dwordx4 v2, s[40:43], s9 offen lds
    s_add_u32 s9, s9, s11
    v_mfma_f32_32x32x16_bf16 v[32:47], v[96:99], a[68:71], v[32:47]
    v_mfma_f32_32x32x16_bf16 v[48:63], v[100:103], a[68:71], v[48:63]
    ds_read_b128 a[76:79], v5 offset:24576
    ds_read_b128 v[92:95], v6 offset:24576
    ds_read_b128 v[96:99], v6 offset:25600
    ds_read_b128 v[100:103], v7 offset:19456
    s_waitcnt lgkmcnt(4)
    v_mfma_f32_32x32x16_bf16 v[16:31], v[80:83], a[72:75], v[16:31]
    s_add_u32 m0, s8, 81920
    s_nop 0
    buffer_load_dwordx4 v2, s[40:43], s9 offen lds
    s_add_u32 s9, s9, s11
    v_mfma_f32_32x32x16_bf16 v[32:47], v[84:87], a[72:75], v[32:47]
    v_mfma_f32_32x32x16_bf16 v[48:63], v[88:91], a[72:75], v[48:63]
    s_waitcnt vmcnt(9)
    s_barrier
    ds_read_b128 a[80:83], v5 offset:32768
    ds_read_b128 v[80:83], v6 offset:32768
    ds_read_b128 v[84:87], v6 offset:33792
    ds_read_b128 v[88:91], v7 offset:20480
    s_waitcnt lgkmcnt(4)
    v_mfma_f32_32x32x16_bf16 v[16:31], v[92:95], a[76:79], v[16:31]
    s_add_u32 m0, s8, 90112
    s_nop 0
    buffer_load_dwordx4 v2, s[40:43], s9 offen lds
    s_add_u32 s9, s9, s11
    v_mfma_f32_32x32x16_bf16 v[32:47], v[96:99], a[76:79], v[32:47]
    v_mfma_f32_32x32x16_bf16 v[48:63], v[100:103], a[76:79], v[48:63]
    ds_read_b128 a[84:87], v5 offset:40960
    ds_read_b128 v[92:95], v6 offset:40960
    ds_read_b128 v[96:99], v6 offset:41984
    ds_read_b128 v[100:103], v7 offset:21504
    s_waitcnt lgkmcnt(4)
    v_mfma_f32_32x32x16_bf16 v[16:31], v[80:83], a[80:83], v[16:31]
    s_add_u32 m0, s8, 98304
    s_nop 0
    buffer_load_dwordx4 v2, s[40:43], s9 offen lds
    s_add_u32 s9, s9, s11
    v_mfma_f32_32x32x16_bf16 v[32:47], v[84:87], a[80:83], v[32:47]
    v_mfma_f32_32x32x16_bf16 v[48:63], v[88:91], a[80:83], v[48:63]
    s_waitcnt vmcnt(9)
    s_barrier
    ds_read_b128 a[88:91], v5 offset:49152
    ds_read_b128 v[80:83], v6 offset:49152
    ds_read_b128 v[84:87], v6 offset:50176
    ds_read_b128 v[88:91], v7 offset:22528
    s_waitcnt lgkmcnt(4)
    v_mfma_f32_32x32x16_bf16 v[16:31], v[92:95], a[84:87], v[16:31]
    s_add_u32 m0, s8, 106496
    s_nop 0
    buffer_load_dwordx4 v2, s[40:43], s9 offen lds
    s_add_u32 s9, s9, s11
    v_mfma_f32_32x32x16_bf16 v[32:47], v[96:99], a[84:87], v[32:47]
    v_mfma_f32_32x32x16_bf16 v[48:63], v[100:103], a[84:87], v[48:63]
    ds_read_b128 a[92:95], v5 offset:57344
    ds_read_b128 v[92:95], v6 offset:57344
    ds_read_b128 v[96:99], v6 offset:58368
    ds_read_b128 v[100:103], v7 offset:23552
    s_waitcnt lgkmcnt(4)
    v_mfma_f32_32x32x16_bf16 v[16:31], v[80:83], a[88:91], v[16:31]
    s_add_u32 m0, s8, 114688
    s_nop 0
    buffer_load_dwordx4 v2, s[40:43], s9 offen lds
    s_add_u32 s9, s9, s11
    v_mfma_f32_32x32x16_bf16 v[32:47], v[84:87], a[88:91], v[32:47]
    v_mfma_f32_32x32x16_bf16 v[48:63], v[88:91], a[88:91], v[48:63]
    s_waitcnt vmcnt(5)
    s_barrier
    ds_read_b128 a[96:99], v0 offset:0
    ds_read_b128 v[80:83], v1 offset:0
    ds_read_b128 v[84:87], v1 offset:1024
    ds_read_b128 v[88:91], v7 offset:24576
    s_waitcnt lgkmcnt(4)
    v_mfma_f32_32x32x16_bf16 v[16:31], v[92:95], a[92:95], v[16:31]
    s_add_u32 m0, s8, 122880
    s_nop 0
    buffer_load_dwordx4 v2, s[40:43], s9 offen lds
    s_add_u32 s9, s9, s11
    v_mfma_f32_32x32x16_bf16 v[32:47], v[96:99], a[92:95], v[32:47]
    v_mfma_f32_32x32x16_bf16 v[48:63], v[100:103], a[92:95], v[48:63]
    ds_read_b128 a[100:103], v0 offset:8192
    ds_read_b128 v[92:95], v1 offset:8192
    ds_read_b128 v[96:99], v1 offset:9216
    ds_read_b128 v[100:103], v7 offset:25600
    s_waitcnt lgkmcnt(4)
    v_mfma_f32_32x32x16_bf16 v[16:31], v[80:83], a[96:99], v[16:31]
    v_mfma_f32_32x32x16_bf16 v[32:47], v[84:87], a[96:99], v[32:47]
    v_mfma_f32_32x32x16_bf16 v[48:63], v[88:91], a[96:99], v[48:63]
    s_waitcnt vmcnt(4)
    s_barrier
    ds_read_b128 a[104:107], v0 offset:16384
    ds_read_b128 v[80:83], v1 offset:16384
    ds_read_b128 v[84:87], v1 offset:17408
    ds_read_b128 v[88:91], v7 offset:26624
    s_waitcnt lgkmcnt(4)
    v_mfma_f32_32x32x16_bf16 v[16:31], v[92:95], a[100:103], v[16:31]
    v_mfma_f32_32x32x16_bf16 v[32:47], v[96:99], a[100:103], v[32:47]
    v_mfma_f32_32x32x16_bf16 v[48:63], v[100:103], a[100:103], v[48:63]
    ds_read_b128 a[108:111], v0 offset:24576
    ds_read_b128 v[92:95], v1 offset:24576
    ds_read_b128 v[96:99], v1 offset:25600
    ds_read_b128 v[100:103], v7 offset:27648
    s_waitcnt lgkmcnt(4)
    v_mfma_f32_32x32x16_bf16 v[16:31], v[80:83], a[104:107], v[16:31]
    s_add_u32 m0, s8, 0
    s_add_u32 s13, s12, 6144
    buffer_load_dwordx4 v2, s[40:43], s13 offen lds
    v_mfma_f32_32x32x16_bf16 v[32:47], v[84:87], a[104:107], v[32:47]
    v_mfma_f32_32x32x16_bf16 v[48:63], v[88:91], a[104:107], v[48:63]
    s_waitcnt vmcnt(3)
    s_barrier
    ds_read_b128 a[112:115], v0 offset:32768
    ds_read_b128 v[80:83], v1 offset:32768
    ds_read_b128 v[84:87], v1 offset:33792
    ds_read_b128 v[88:91], v7 offset:28672
    s_waitcnt lgkmcnt(4)
    v_mfma_f32_32x32x16_bf16 v[16:31], v[92:95], a[108:111], v[16:31]
    s_add_u32 m0, s8, 8192
    s_add_u32 s13, s12, 63488
    buffer_load_dwordx4 v2, s[40:43], s13 offen lds
    v_mfma_f32_32x32x16_bf16 v[32:47], v[96:99], a[108:111], v[32:47]
    v_mfma_f32_32x32x16_bf16 v[48:63], v[100:103], a[108:111], v[48:63]
    ds_read_b128 a[116:119], v0 offset:40960
    ds_read_b128 v[92:95], v1 offset:40960
    ds_read_b128 v[96:99], v1 offset:41984
    ds_read_b128 v[100:103], v7 offset:29696
    s_waitcnt lgkmcnt(4)
    v_mfma_f32_32x32x16_bf16 v[16:31], v[80:83], a[112:115], v[16:31]
    s_add_u32 m0, s8, 16384
    s_add_u32 s13, s12, 120832
    buffer_load_dwordx4 v2, s[40:43], s13 offen lds
    v_mfma_f32_32x32x16_bf16 v[32:47], v[84:87], a[112:115], v[32:47]
    v_mfma_f32_32x32x16_bf16 v[48:63], v[88:91], a[112:115], v[48:63]
    s_waitcnt vmcnt(3)
    s_barrier
    ds_read_b128 a[120:123], v0 offset:49152
    ds_read_b128 v[80:83], v1 offset:49152
    ds_read_b128 v[84:87], v1 offset:50176
    ds_read_b128 v[88:91], v7 offset:30720
    s_waitcnt lgkmcnt(4)
    v_mfma_f32_32x32x16_bf16 v[16:31], v[92:95], a[116:119], v[16:31]
    s_add_u32 m0, s8, 24576
    s_add_u32 s13, s12, 178176
    buffer_load_dwordx4 v2, s[40:43], s13 offen lds
    v_mfma_f32_32x32x16_bf16 v[32:47], v[96:99], a[116:119], v[32:47]
    v_mfma_f32_32x32x16_bf16 v[48:63], v[100:103], a[116:119], v[48:63]
    ds_read_b128 a[124:127], v0 offset:57344
    ds_read_b128 v[92:95], v1 offset:57344
    ds_read_b128 v[96:99], v1 offset:58368
    ds_read_b128 v[100:103], v7 offset:31744
    s_waitcnt lgkmcnt(4)
    v_mfma_f32_32x32x16_bf16 v[16:31], v[80:83], a[120:123], v[16:31]
    v_mfma_f32_32x32x16_bf16 v[32:47], v[84:87], a[120:123], v[32:47]
    v_mfma_f32_32x32x16_bf16 v[48:63], v[88:91], a[120:123], v[48:63]
    s_waitcnt lgkmcnt(0)
    v_mfma_f32_32x32x16_bf16 v[16:31], v[92:95], a[124:127], v[16:31]
    v_mfma_f32_32x32x16_bf16 v[32:47], v[96:99], a[124:127], v[32:47]
    v_mfma_f32_32x32x16_bf16 v[48:63], v[100:103], a[124:127], v[48:63]
    s_waitcnt vmcnt(11)
    v_mfma_f32_32x32x16_bf16 v[16:31], v[108:111], v[104:107], v[16:31]
    v_mfma_f32_32x32x16_bf16 v[32:47], v[112:115], v[104:107], v[32:47]
    v_mfma_f32_32x32x16_bf16 v[48:63], v[116:119], v[104:107], v[48:63]
    s_add_u32 m0, s8, 32768
    s_add_u32 s13, s12, 3072
    buffer_load_dwordx4 v2, s[40:43], s13 offen lds
    s_add_u32 m0, s8, 40960
    s_add_u32 s13, s12, 60416
    buffer_load_dwordx4 v2, s[40:43], s13 offen lds
    s_add_u32 m0, s8, 49152
    s_add_u32 s13, s12, 117760
    buffer_load_dwordx4 v2, s[40:43], s13 offen lds
    s_add_u32 m0, s8, 57344
    s_add_u32 s13, s12, 175104
    buffer_load_dwordx4 v2, s[40:43], s13 offen lds
    v_lshrrev_b32 v1, 4, v2
    s_getpc_b64 s[44:45]
L_pc_k4_ffn1_kernel:
    s_lshr_b32 s46, s2, 3
    s_mul_i32 s46, s46, 8
    s_add_u32 s46, s46, s3
    s_lshl_b32 s46, s46, 13
    v_lshlrev_b32 v8, 7, v1
    v_add_u32 v8, s46, v8
    v_min_u32 v8, L_code_end-k5_down_kernel-4, v8
    v_add_u32 v8, k5_down_kernel-L_pc_k4_ffn1_kernel, v8
    global_load_dword v9, v8, s[44:45]
    s_waitcnt vmcnt(5)
    s_barrier
    v_mul_f32 v108, v16, v16
    v_mul_f32 v109, v17, v17
    v_mul_f32 v110, v18, v18
    v_mul_f32 v111, v19, v19
    v_mul_f32 v112, v20, v20
    v_mul_f32 v113, v21, v21
    v_mul_f32 v114, v22, v22
    v_mul_f32 v115, v23, v23
    v_fma_f32 v108, v108, v13, v12
    v_fma_f32 v109, v109, v13, v12
    v_fma_f32 v110, v110, v13, v12
    v_fma_f32 v111, v111, v13, v12
    v_fma_f32 v112, v112, v13, v12
    v_fma_f32 v113, v113, v13, v12
    v_fma_f32 v114, v114, v13, v12
    v_fma_f32 v115, v115, v13, v12
    v_mul_f32 v108, v108, v16
    v_mul_f32 v109, v109, v17
    v_mul_f32 v110, v110, v18
    v_mul_f32 v111, v111, v19
    v_mul_f32 v112, v112, v20
    v_mul_f32 v113, v113, v21
    v_mul_f32 v114, v114, v22
    v_mul_f32 v115, v115, v23
    v_exp_f32 v108, v108
    v_exp_f32 v109, v109
    v_exp_f32 v110, v110
    v_exp_f32 v111, v111
    v_exp_f32 v112, v112
    v_exp_f32 v113, v113
    v_exp_f32 v114, v114
    v_exp_f32 v115, v115
    v_mul_f32 v24, v24, v16
    v_mul_f32 v25, v25, v17
    v_mul_f32 v26, v26, v18
    v_mul_f32 v27, v27, v19
    v_mul_f32 v28, v28, v20
    v_mul_f32 v29, v29, v21
    v_mul_f32 v30, v30, v22
    v_mul_f32 v31, v31, v23
    v_fma_f32 v108, v108, v10, v10
    v_fma_f32 v109, v109, v10, v10
    v_fma_f32 v110, v110, v10, v10
    v_fma_f32 v111, v111, v10, v10
    v_fma_f32 v112, v112, v10, v10
    v_fma_f32 v113, v113, v10, v10
    v_fma_f32 v114, v114, v10, v10
    v_fma_f32 v115, v115, v10, v10
    v_rcp_f32 v108, v108
    v_rcp_f32 v109, v109
    v_rcp_f32 v110, v110
    v_rcp_f32 v111, v111
    v_rcp_f32 v112, v112
    v_rcp_f32 v113, v113
    v_rcp_f32 v114, v114
    v_rcp_f32 v115, v115
    v_mul_f32 v108, v108, v24
    v_mul_f32 v109, v109, v25
    v_mul_f32 v110, v110, v26
    v_mul_f32 v111, v111, v27
    v_mul_f32 v112, v112, v28
    v_mul_f32 v113, v113, v29
    v_mul_f32 v114, v114, v30
    v_mul_f32 v115, v115, v31
    v_cvt_pk_bf16_f32 v116, v108, v109
    v_cvt_pk_bf16_f32 v117, v110, v111
    v_cvt_pk_bf16_f32 v118, v112, v113
    v_cvt_pk_bf16_f32 v119, v114, v115
    buffer_store_dwordx4 v[116:119], v2, s[40:43], s60 offen offset:0 sc1
    v_mul_f32 v108, v32, v32
    v_mul_f32 v109, v33, v33
    v_mul_f32 v110, v34, v34
    v_mul_f32 v111, v35, v35
    v_mul_f32 v112, v36, v36
    v_mul_f32 v113, v37, v37
    v_mul_f32 v114, v38, v38
    v_mul_f32 v115, v39, v39
    v_fma_f32 v108, v108, v13, v12
    v_fma_f32 v109, v109, v13, v12
    v_fma_f32 v110, v110, v13, v12
    v_fma_f32 v111, v111, v13, v12
    v_fma_f32 v112, v112, v13, v12
    v_fma_f32 v113, v113, v13, v12
    v_fma_f32 v114, v114, v13, v12
    v_fma_f32 v115, v115, v13, v12
    v_mul_f32 v108, v108, v32
    v_mul_f32 v109, v109, v33
    v_mul_f32 v110, v110, v34
    v_mul_f32 v111, v111, v35
    v_mul_f32 v112, v112, v36
    v_mul_f32 v113, v113, v37
    v_mul_f32 v114, v114, v38
    v_mul_f32 v115, v115, v39
    v_exp_f32 v108, v108
    v_exp_f32 v109, v109
    v_exp_f32 v110, v110
    v_exp_f32 v111, v111
    v_exp_f32 v112, v112
    v_exp_f32 v113, v113
    v_exp_f32 v114, v114
    v_exp_f32 v115, v115
    v_mul_f32 v40, v40, v32
    v_mul_f32 v41, v41, v33
    v_mul_f32 v42, v42, v34
    v_mul_f32 v43, v43, v35
    v_mul_f32 v44, v44, v36
    v_mul_f32 v45, v45, v37
    v_mul_f32 v46, v46, v38
    v_mul_f32 v47, v47, v39
    v_fma_f32 v108, v108, v10, v10
    v_fma_f32 v109, v109, v10, v10
    v_fma_f32 v110, v110, v10, v10
    v_fma_f32 v111, v111, v10, v10
    v_fma_f32 v112, v112, v10, v10
    v_fma_f32 v113, v113, v10, v10
    v_fma_f32 v114, v114, v10, v10
    v_fma_f32 v115, v115, v10, v10
    v_rcp_f32 v108, v108
    v_rcp_f32 v109, v109
    v_rcp_f32 v110, v110
    v_rcp_f32 v111, v111
    v_rcp_f32 v112, v112
    v_rcp_f32 v113, v113
    v_rcp_f32 v114, v114
    v_rcp_f32 v115, v115
    v_mul_f32 v108, v108, v40
    v_mul_f32 v109, v109, v41
    v_mul_f32 v110, v110, v42
    v_mul_f32 v111, v111, v43
    v_mul_f32 v112, v112, v44
    v_mul_f32 v113, v113, v45
    v_mul_f32 v114, v114, v46
    v_mul_f32 v115, v115, v47
    v_cvt_pk_bf16_f32 v120, v108, v109
    v_cvt_pk_bf16_f32 v121, v110, v111
    v_cvt_pk_bf16_f32 v122, v112, v113
    v_cvt_pk_bf16_f32 v123, v114, v115
    buffer_store_dwordx4 v[120:123], v2, s[40:43], s60 offen offset:1024 sc1
    v_mul_f32 v108, v48, v48
    v_mul_f32 v109, v49, v49
    v_mul_f32 v110, v50, v50
    v_mul_f32 v111, v51, v51
    v_mul_f32 v112, v52, v52
    v_mul_f32 v113, v53, v53
    v_mul_f32 v114, v54, v54
    v_mul_f32 v115, v55, v55
    v_fma_f32 v108, v108, v13, v12
    v_fma_f32 v109, v109, v13, v12
    v_fma_f32 v110, v110, v13, v12
    v_fma_f32 v111, v111, v13, v12
    v_fma_f32 v112, v112, v13, v12
    v_fma_f32 v113, v113, v13, v12
    v_fma_f32 v114, v114, v13, v12
    v_fma_f32 v115, v115, v13, v12
    v_mul_f32 v108, v108, v48
    v_mul_f32 v109, v109, v49
    v_mul_f32 v110, v110, v50
    v_mul_f32 v111, v111, v51
    v_mul_f32 v112, v112, v52
    v_mul_f32 v113, v113, v53
    v_mul_f32 v114, v114, v54
    v_mul_f32 v115, v115, v55
    v_exp_f32 v108, v108
    v_exp_f32 v109, v109
    v_exp_f32 v110, v110
    v_exp_f32 v111, v111
    v_exp_f32 v112, v112
    v_exp_f32 v113, v113
    v_exp_f32 v114, v114
    v_exp_f32 v115, v115
    v_mul_f32 v56, v56, v48
    v_mul_f32 v57, v57, v49
    v_mul_f32 v58, v58, v50
    v_mul_f32 v59, v59, v51
    v_mul_f32 v60, v60, v52
    v_mul_f32 v61, v61, v53
    v_mul_f32 v62, v62, v54
    v_mul_f32 v63, v63, v55
    v_fma_f32 v108, v108, v10, v10
    v_fma_f32 v109, v109, v10, v10
    v_fma_f32 v110, v110, v10, v10
    v_fma_f32 v111, v111, v10, v10
    v_fma_f32 v112, v112, v10, v10
    v_fma_f32 v113, v113, v10, v10
    v_fma_f32 v114, v114, v10, v10
    v_fma_f32 v115, v115, v10, v10
    v_rcp_f32 v108, v108
    v_rcp_f32 v109, v109
    v_rcp_f32 v110, v110
    v_rcp_f32 v111, v111
    v_rcp_f32 v112, v112
    v_rcp_f32 v113, v113
    v_rcp_f32 v114, v114
    v_rcp_f32 v115, v115
    v_mul_f32 v108, v108, v56
    v_mul_f32 v109, v109, v57
    v_mul_f32 v110, v110, v58
    v_mul_f32 v111, v111, v59
    v_mul_f32 v112, v112, v60
    v_mul_f32 v113, v113, v61
    v_mul_f32 v114, v114, v62
    v_mul_f32 v115, v115, v63
    v_cvt_pk_bf16_f32 v116, v108, v109
    v_cvt_pk_bf16_f32 v117, v110, v111
    v_cvt_pk_bf16_f32 v118, v112, v113
    v_cvt_pk_bf16_f32 v119, v114, v115
    buffer_store_dwordx4 v[116:119], v2, s[40:43], s60 offen offset:2048 sc1
    s_waitcnt vmcnt(4)
    s_barrier
    ds_read_b128 v[80:83], v15 offset:0
    ds_read_b128 v[84:87], v15 offset:1024
    ds_read_b128 v[88:91], v15 offset:2048
    ds_read_b128 v[92:95], v15 offset:3072
    ds_read_b128 v[96:99], v15 offset:4096
    v_mfma_f32_32x32x16_bf16 v[64:79], v[124:127], v[104:107], 0
    ds_read_b128 v[100:103], v15 offset:5120
    s_waitcnt lgkmcnt(5)
    v_mfma_f32_32x32x16_bf16 v[64:79], v[80:83], a[0:3], v[64:79]
    ds_read_b128 v[80:83], v15 offset:6144
    s_waitcnt lgkmcnt(5)
    v_mfma_f32_32x32x16_bf16 v[64:79], v[84:87], a[4:7], v[64:79]
    ds_read_b128 v[84:87], v15 offset:7168
    s_waitcnt lgkmcnt(5)
    v_mfma_f32_32x32x16_bf16 v[64:79], v[88:91], a[8:11], v[64:79]
    ds_read_b128 v[88:91], v15 offset:8192
    s_waitcnt lgkmcnt(5)
    v_mfma_f32_32x32x16_bf16 v[64:79], v[92:95], a[12:15], v[64:79]
    ds_read_b128 v[92:95], v15 offset:9216
    s_waitcnt lgkmcnt(5)
    v_mfma_f32_32x32x16_bf16 v[64:79], v[96:99], a[16:19], v[64:79]
    ds_read_b128 v[96:99], v15 offset:10240
    s_waitcnt lgkmcnt(5)
    v_mfma_f32_32x32x16_bf16 v[64:79], v[100:103], a[20:23], v[64:79]
    ds_read_b128 v[100:103], v15 offset:11264
    s_waitcnt lgkmcnt(5)
    v_mfma_f32_32x32x16_bf16 v[64:79], v[80:83], a[24:27], v[64:79]
    ds_read_b128 v[80:83], v15 offset:12288
    s_waitcnt lgkmcnt(5)
    v_mfma_f32_32x32x16_bf16 v[64:79], v[84:87], a[28:31], v[64:79]
    ds_read_b128 v[84:87], v15 offset:13312
    s_waitcnt lgkmcnt(5)
    v_mfma_f32_32x32x16_bf16 v[64:79], v[88:91], a[32:35], v[64:79]
    ds_read_b128 v[88:91], v15 offset:14336
    s_waitcnt lgkmcnt(5)
    v_mfma_f32_32x32x16_bf16 v[64:79], v[92:95], a[36:39], v[64:79]
    ds_read_b128 v[92:95], v15 offset:15360
    s_waitcnt lgkmcnt(5)
    v_mfma_f32_32x32x16_bf16 v[64:79], v[96:99], a[40:43], v[64:79]
    ds_read_b128 v[96:99], v15 offset:16384
    s_waitcnt lgkmcnt(5)
    v_mfma_f32_32x32x16_bf16 v[64:79], v[100:103], a[44:47], v[64:79]
    ds_read_b128 v[100:103], v15 offset:17408
    s_waitcnt lgkmcnt(5)
    v_mfma_f32_32x32x16_bf16 v[64:79], v[80:83], a[48:51], v[64:79]
    ds_read_b128 v[80:83], v15 offset:18432
    s_waitcnt lgkmcnt(5)
    v_mfma_f32_32x32x16_bf16 v[64:79], v[84:87], a[52:55], v[64:79]
    ds_read_b128 v[84:87], v15 offset:19456
    s_waitcnt lgkmcnt(5)
    v_mfma_f32_32x32x16_bf16 v[64:79], v[88:91], a[56:59], v[64:79]
    ds_read_b128 v[88:91], v15 offset:20480
    s_waitcnt lgkmcnt(5)
    v_mfma_f32_32x32x16_bf16 v[64:79], v[92:95], a[60:63], v[64:79]
    ds_read_b128 v[92:95], v15 offset:21504
    s_waitcnt lgkmcnt(5)
    v_mfma_f32_32x32x16_bf16 v[64:79], v[96:99], a[64:67], v[64:79]
    ds_read_b128 v[96:99], v15 offset:22528
    s_waitcnt lgkmcnt(5)
    v_mfma_f32_32x32x16_bf16 v[64:79], v[100:103], a[68:71], v[64:79]
    ds_read_b128 v[100:103], v15 offset:23552
    s_waitcnt lgkmcnt(5)
    v_mfma_f32_32x32x16_bf16 v[64:79], v[80:83], a[72:75], v[64:79]
    ds_read_b128 v[80:83], v15 offset:24576
    s_waitcnt lgkmcnt(5)
    v_mfma_f32_32x32x16_bf16 v[64:79], v[84:87], a[76:79], v[64:79]
    ds_read_b128 v[84:87], v15 offset:25600
    s_waitcnt lgkmcnt(5)
    v_mfma_f32_32x32x16_bf16 v[64:79], v[88:91], a[80:83], v[64:79]
    ds_read_b128 v[88:91], v15 offset:26624
    s_waitcnt lgkmcnt(5)
    v_mfma_f32_32x32x16_bf16 v[64:79], v[92:95], a[84:87], v[64:79]
    ds_read_b128 v[92:95], v15 offset:27648
    s_waitcnt lgkmcnt(5)
    v_mfma_f32_32x32x16_bf16 v[64:79], v[96:99], a[88:91], v[64:79]
    ds_read_b128 v[96:99], v15 offset:28672
    s_waitcnt lgkmcnt(5)
    v_mfma_f32_32x32x16_bf16 v[64:79], v[100:103], a[92:95], v[64:79]
    ds_read_b128 v[100:103], v15 offset:29696
    s_waitcnt lgkmcnt(5)
    v_mfma_f32_32x32x16_bf16 v[64:79], v[80:83], a[96:99], v[64:79]
    ds_read_b128 v[80:83], v15 offset:30720
    s_waitcnt lgkmcnt(5)
    v_mfma_f32_32x32x16_bf16 v[64:79], v[84:87], a[100:103], v[64:79]
    ds_read_b128 v[84:87], v15 offset:31744
    s_waitcnt lgkmcnt(5)
    v_mfma_f32_32x32x16_bf16 v[64:79], v[88:91], a[104:107], v[64:79]
    s_waitcnt lgkmcnt(4)
    v_mfma_f32_32x32x16_bf16 v[64:79], v[92:95], a[108:111], v[64:79]
    s_waitcnt lgkmcnt(3)
    v_mfma_f32_32x32x16_bf16 v[64:79], v[96:99], a[112:115], v[64:79]
    s_waitcnt lgkmcnt(2)
    v_mfma_f32_32x32x16_bf16 v[64:79], v[100:103], a[116:119], v[64:79]
    s_waitcnt lgkmcnt(1)
    v_mfma_f32_32x32x16_bf16 v[64:79], v[80:83], a[120:123], v[64:79]
    s_waitcnt lgkmcnt(0)
    v_mfma_f32_32x32x16_bf16 v[64:79], v[84:87], a[124:127], v[64:79]
    s_nop 11
    v_mul_f32 v108, v64, v64
    v_mul_f32 v109, v65, v65
    v_mul_f32 v110, v66, v66
    v_mul_f32 v111, v67, v67
    v_mul_f32 v112, v68, v68
    v_mul_f32 v113, v69, v69
    v_mul_f32 v114, v70, v70
    v_mul_f32 v115, v71, v71
    v_fma_f32 v108, v108, v13, v12
    v_fma_f32 v109, v109, v13, v12
    v_fma_f32 v110, v110, v13, v12
    v_fma_f32 v111, v111, v13, v12
    v_fma_f32 v112, v112, v13, v12
    v_fma_f32 v113, v113, v13, v12
    v_fma_f32 v114, v114, v13, v12
    v_fma_f32 v115, v115, v13, v12
    v_mul_f32 v108, v108, v64
    v_mul_f32 v109, v109, v65
    v_mul_f32 v110, v110, v66
    v_mul_f32 v111, v111, v67
    v_mul_f32 v112, v112, v68
    v_mul_f32 v113, v113, v69
    v_mul_f32 v114, v114, v70
    v_mul_f32 v115, v115, v71
    v_exp_f32 v108, v108
    v_exp_f32 v109, v109
    v_exp_f32 v110, v110
    v_exp_f32 v111, v111
    v_exp_f32 v112, v112
    v_exp_f32 v113, v113
    v_exp_f32 v114, v114
    v_exp_f32 v115, v115
    v_mul_f32 v72, v72, v64
    v_mul_f32 v73, v73, v65
    v_mul_f32 v74, v74, v66
    v_mul_f32 v75, v75, v67
    v_mul_f32 v76, v76, v68
    v_mul_f32 v77, v77, v69
    v_mul_f32 v78, v78, v70
    v_mul_f32 v79, v79, v71
    v_fma_f32 v108, v108, v10, v10
    v_fma_f32 v109, v109, v10, v10
    v_fma_f32 v110, v110, v10, v10
    v_fma_f32 v111, v111, v10, v10
    v_fma_f32 v112, v112, v10, v10
    v_fma_f32 v113, v113, v10, v10
    v_fma_f32 v114, v114, v10, v10
    v_fma_f32 v115, v115, v10, v10
    v_rcp_f32 v108, v108
    v_rcp_f32 v109, v109
    v_rcp_f32 v110, v110
    v_rcp_f32 v111, v111
    v_rcp_f32 v112, v112
    v_rcp_f32 v113, v113
    v_rcp_f32 v114, v114
    v_rcp_f32 v115, v115
    v_mul_f32 v108, v108, v72
    v_mul_f32 v109, v109, v73
    v_mul_f32 v110, v110, v74
    v_mul_f32 v111, v111, v75
    v_mul_f32 v112, v112, v76
    v_mul_f32 v113, v113, v77
    v_mul_f32 v114, v114, v78
    v_mul_f32 v115, v115, v79
    v_cvt_pk_bf16_f32 v120, v108, v109
    v_cvt_pk_bf16_f32 v121, v110, v111
    v_cvt_pk_bf16_f32 v122, v112, v113
    v_cvt_pk_bf16_f32 v123, v114, v115
    buffer_store_dwordx4 v[120:123], v2, s[40:43], s60 offen offset:3072 sc1
    s_branch L_k4_done
    s_nop 0
L_k4_g1:
    s_add_u32 m0, s8, 0
    s_nop 0
    buffer_load_dwordx4 v2, s[40:43], s9 offen lds
    s_add_u32 s9, s9, s11
    s_add_u32 m0, s8, 131072
    s_add_u32 s13, s12, 2048
    buffer_load_dwordx4 v2, s[40:43], s13 offen lds
    s_add_u32 m0, s8, 8192
    s_nop 0
    buffer_load_dwordx4 v2, s[40:43], s9 offen lds
    s_add_u32 s9, s9, s11
    s_add_u32 m0, s8, 16384
    s_nop 0
    buffer_load_dwordx4 v2, s[40:43], s9 offen lds
    s_add_u32 s9, s9, s11
    s_add_u32 m0, s8, 24576
    s_nop 0
    buffer_load_dwordx4 v2, s[40:43], s9 offen lds
    s_add_u32 s9, s9, s11
    s_add_u32 m0, s8, 32768
    s_nop 0
    buffer_load_dwordx4 v2, s[40:43], s9 offen lds
    s_add_u32 s9, s9, s11
    s_add_u32 m0, s8, 40960
    s_nop 0
    buffer_load_dwordx4 v2, s[40:43], s9 offen lds
    s_add_u32 s9, s9, s11
    s_add_u32 m0, s8, 49152
    s_nop 0
    buffer_load_dwordx4 v2, s[40:43], s9 offen lds
    s_add_u32 s9, s9, s11
    s_add_u32 m0, s8, 57344
    s_nop 0
    buffer_load_dwordx4 v2, s[40:43], s9 offen lds
    s_add_u32 s9, s9, s11
    s_waitcnt vmcnt(6)
    s_barrier
    ds_read_b128 a[0:3], v5 offset:0
    ds_read_b128 v[80:83], v6 offset:0
    ds_read_b128 v[84:87], v6 offset:1024
    ds_read_b128 a[4:7], v5 offset:8192
    ds_read_b128 v[92:95], v6 offset:8192
    ds_read_b128 v[96:99], v6 offset:9216
    s_waitcnt lgkmcnt(3)
    v_mfma_f32_32x32x16_bf16 v[16:31], v[80:83], a[0:3], 0
    s_add_u32 m0, s8, 65536
    s_nop 0
    buffer_load_dwordx4 v2, s[40:43], s9 offen lds
    s_add_u32 s9, s9, s11
    v_mfma_f32_32x32x16_bf16 v[32:47], v[84:87], a[0:3], 0
    s_lshl_b32 s13, s6, 12
    s_add_u32 s13, s13, 11010048
    v_lshlrev_b32 v8, 11, v3
    v_lshl_add_u32 v8, v4, 4, v8
    buffer_load_dwordx4 v[64:67], v8, s[40:43], s13 offen offset:0
    buffer_load_dwordx4 v[68:71], v8, s[40:43], s13 offen offset:512
    buffer_load_dwordx4 v[72:75], v8, s[40:43], s13 offen offset:1024
    buffer_load_dwordx4 v[76:79], v8, s[40:43], s13 offen offset:1536
    s_waitcnt vmcnt(9)
    s_barrier
    ds_read_b128 a[8:11], v5 offset:16384
    ds_read_b128 v[80:83], v6 offset:16384
    ds_read_b128 v[84:87], v6 offset:17408
    s_waitcnt lgkmcnt(3)
    v_mfma_f32_32x32x16_bf16 v[16:31], v[92:95], a[4:7], v[16:31]
    s_add_u32 m0, s8, 73728
    s_nop 0
    buffer_load_dwordx4 v2, s[40:43], s9 offen lds
    s_add_u32 s9, s9, s11
    v_mfma_f32_32x32x16_bf16 v[32:47], v[96:99], a[4:7], v[32:47]
    s_add_u32 m0, s8, 139264
    s_add_u32 s13, s12, 59392
    buffer_load_dwordx4 v2, s[40:43], s13 offen lds
    ds_read_b128 a[12:15], v5 offset:24576
    ds_read_b128 v[92:95], v6 offset:24576
    ds_read_b128 v[96:99], v6 offset:25600
    s_waitcnt lgkmcnt(3)
    v_mfma_f32_32x32x16_bf16 v[16:31], v[80:83], a[8:11], v[16:31]
    s_add_u32 m0, s8, 81920
    s_nop 0
    buffer_load_dwordx4 v2, s[40:43], s9 offen lds
    s_add_u32 s9, s9, s11
    v_mfma_f32_32x32x16_bf16 v[32:47], v[84:87], a[8:11], v[32:47]
    s_waitcnt vmcnt(10)
    s_barrier
    ds_read_b128 a[16:19], v5 offset:32768
    ds_read_b128 v[80:83], v6 offset:32768
    ds_read_b128 v[84:87], v6 offset:33792
    s_waitcnt lgkmcnt(3)
    v_mfma_f32_32x32x16_bf16 v[16:31], v[92:95], a[12:15], v[16:31]
    s_add_u32 m0, s8, 90112
    s_nop 0
    buffer_load_dwordx4 v2, s[40:43], s9 offen lds
    s_add_u32 s9, s9, s11
    v_mfma_f32_32x32x16_bf16 v[32:47], v[96:99], a[12:15], v[32:47]
    ds_read_b128 a[20:23], v5 offset:40960
    ds_read_b128 v[92:95], v6 offset:40960
    ds_read_b128 v[96:99], v6 offset:41984
    s_waitcnt lgkmcnt(3)
    v_mfma_f32_32x32x16_bf16 v[16:31], v[80:83], a[16:19], v[16:31]
    s_add_u32 m0, s8, 98304
    s_nop 0
    buffer_load_dwordx4 v2, s[40:43], s9 offen lds
    s_add_u32 s9, s9, s11
    v_mfma_f32_32x32x16_bf16 v[32:47], v[84:87], a[16:19], v[32:47]
    s_waitcnt vmcnt(10)
    s_barrier
    ds_read_b128 a[24:27], v5 offset:49152
    ds_read_b128 v[80:83], v6 offset:49152
    ds_read_b128 v[84:87], v6 offset:50176
    s_waitcnt lgkmcnt(3)
    v_mfma_f32_32x32x16_bf16 v[16:31], v[92:95], a[20:23], v[16:31]
    s_add_u32 m0, s8, 106496
    s_nop 0
    buffer_load_dwordx4 v2, s[40:43], s9 offen lds
    s_add_u32 s9, s9, s11
    v_mfma_f32_32x32x16_bf16 v[32:47], v[96:99], a[20:23], v[32:47]
    s_add_u32 m0, s8, 147456
    s_add_u32 s13, s12, 116736
    buffer_load_dwordx4 v2, s[40:43], s13 offen lds
    ds_read_b128 a[28:31], v5 offset:57344
    ds_read_b128 v[92:95], v6 offset:57344
    ds_read_b128 v[96:99], v6 offset:58368
    s_waitcnt lgkmcnt(3)
    v_mfma_f32_32x32x16_bf16 v[16:31], v[80:83], a[24:27], v[16:31]
    s_add_u32 m0, s8, 114688
    s_nop 0
    buffer_load_dwordx4 v2, s[40:43], s9 offen lds
    s_add_u32 s9, s9, s11
    v_mfma_f32_32x32x16_bf16 v[32:47], v[84:87], a[24:27], v[32:47]
    s_waitcnt vmcnt(6)
    s_barrier
    ds_read_b128 a[32:35], v0 offset:0
    ds_read_b128 v[80:83], v1 offset:0
    ds_read_b128 v[84:87], v1 offset:1024
    s_waitcnt lgkmcnt(3)
    v_mfma_f32_32x32x16_bf16 v[16:31], v[92:95], a[28:31], v[16:31]
    s_add_u32 m0, s8, 122880
    s_nop 0
    buffer_load_dwordx4 v2, s[40:43], s9 offen lds
    s_add_u32 s9, s9, s11
    v_mfma_f32_32x32x16_bf16 v[32:47], v[96:99], a[28:31], v[32:47]
    ds_read_b128 a[36:39], v0 offset:8192
    ds_read_b128 v[92:95], v1 offset:8192
    ds_read_b128 v[96:99], v1 offset:9216
    s_waitcnt lgkmcnt(3)
    v_mfma_f32_32x32x16_bf16 v[16:31], v[80:83], a[32:35], v[16:31]
    s_add_u32 m0, s8, 0
    s_nop 0
    buffer_load_dwordx4 v2, s[40:43], s9 offen lds
    s_add_u32 s9, s9, s11
    v_mfma_f32_32x32x16_bf16 v[32:47], v[84:87], a[32:35], v[32:47]
    s_waitcnt vmcnt(6)
    s_barrier
    ds_read_b128 a[40:43], v0 offset:16384
    ds_read_b128 v[80:83], v1 offset:16384
    ds_read_b128 v[84:87], v1 offset:17408
    s_waitcnt lgkmcnt(3)
    v_mfma_f32_32x32x16_bf16 v[16:31], v[92:95], a[36:39], v[16:31]
    s_add_u32 m0, s8, 8192
    s_nop 0
    buffer_load_dwordx4 v2, s[40:43], s9 offen lds
    s_add_u32 s9, s9, s11
    v_mfma_f32_32x32x16_bf16 v[32:47], v[96:99], a[36:39], v[32:47]
    ds_read_b128 a[44:47], v0 offset:24576
    ds_read_b128 v[92:95], v1 offset:24576
    ds_read_b128 v[96:99], v1 offset:25600
    s_waitcnt lgkmcnt(3)
    v_mfma_f32_32x32x16_bf16 v[16:31], v[80:83], a[40:43], v[16:31]
    s_add_u32 m0, s8, 16384
    s_nop 0
    buffer_load_dwordx4 v2, s[40:43], s9 offen lds
    s_add_u32 s9, s9, s11
    v_mfma_f32_32x32x16_bf16 v[32:47], v[84:87], a[40:43], v[32:47]
    s_add_u32 m0, s8, 155648
    s_add_u32 s13, s12, 174080
    buffer_load_dwordx4 v2, s[40:43], s13 offen lds
    s_waitcnt vmcnt(7)
    s_barrier
    ds_read_b128 a[48:51], v0 offset:32768
    ds_read_b128 v[80:83], v1 offset:32768
    ds_read_b128 v[84:87], v1 offset:33792
    s_waitcnt lgkmcnt(3)
    v_mfma_f32_32x32x16_bf16 v[16:31], v[92:95], a[44:47], v[16:31]
    s_add_u32 m0, s8, 24576
    s_nop 0
    buffer_load_dwordx4 v2, s[40:43], s9 offen lds
    s_add_u32 s9, s9, s11
    v_add_f32 v8, v64, v66
    v_add_f32 v8, v8, v68
    v_add_f32 v8, v8, v70
    v_add_f32 v8, v8, v72
    v_mfma_f32_32x32x16_bf16 v[32:47], v[96:99], a[44:47], v[32:47]
    v_add_f32 v8, v8, v74
    v_add_f32 v8, v8, v76
    v_add_f32 v8, v8, v78
    v_mov_b32 v9, v8
    ds_read_b128 a[52:55], v0 offset:40960
    ds_read_b128 v[92:95], v1 offset:40960
    ds_read_b128 v[96:99], v1 offset:41984
    s_waitcnt lgkmcnt(3)
    v_mfma_f32_32x32x16_bf16 v[16:31], v[80:83], a[48:51], v[16:31]
    s_add_u32 m0, s8, 32768
    s_nop 0
    buffer_load_dwordx4 v2, s[40:43], s9 offen lds
    s_add_u32 s9, s9, s11
    v_permlane32_swap_b32 v8, v9
    v_add_f32 v8, v8, v9
    v_mul_f32 v8, 1031798784, v8
    v_add_f32 v9, v65, v67
    v_mfma_f32_32x32x16_bf16 v[32:47], v[84:87], a[48:51], v[32:47]
    v_add_f32 v9, v9, v69
    v_add_f32 v9, v9, v71
    v_add_f32 v9, v9, v73
    v_add_f32 v9, v9, v75
    s_waitcnt vmcnt(6)
    s_barrier
    ds_read_b128 a[56:59], v0 offset:49152
    ds_read_b128 v[80:83], v1 offset:49152
    ds_read_b128 v[84:87], v1 offset:50176
    s_waitcnt lgkmcnt(3)
    v_mfma_f32_32x32x16_bf16 v[16:31], v[92:95], a[52:55], v[16:31]
    s_add_u32 m0, s8, 40960
    s_nop 0
    buffer_load_dwordx4 v2, s[40:43], s9 offen lds
    s_add_u32 s9, s9, s11
    v_add_f32 v9, v9, v77
    v_add_f32 v9, v9, v79
    v_mov_b32 v10, 0
    v_sub_f32 v64, v64, v8
    v_mfma_f32_32x32x16_bf16 v[32:47], v[96:99], a[52:55], v[32:47]
    v_fmac_f32 v10, v64, v64
    v_sub_f32 v66, v66, v8
    v_fmac_f32 v10, v66, v66
    v_sub_f32 v68, v68, v8
    ds_read_b128 a[60:63], v0 offset:57344
    ds_read_b128 v[92:95], v1 offset:57344
    ds_read_b128 v[96:99], v1 offset:58368
    s_waitcnt lgkmcnt(3)
    v_mfma_f32_32x32x16_bf16 v[16:31], v[80:83], a[56:59], v[16:31]
    s_add_u32 m0, s8, 49152
    s_nop 0
    buffer_load_dwordx4 v2, s[40:43], s9 offen lds
    s_add_u32 s9, s9, s11
    v_fmac_f32 v10, v68, v68
    v_sub_f32 v70, v70, v8
    v_fmac_f32 v10, v70, v70
    v_sub_f32 v72, v72, v8
    v_mfma_f32_32x32x16_bf16 v[32:47], v[84:87], a[56:59], v[32:47]
    v_fmac_f32 v10, v72, v72
    v_sub_f32 v74, v74, v8
    v_fmac_f32 v10, v74, v74
    v_sub_f32 v76, v76, v8
    s_waitcnt vmcnt(6)
    s_barrier
    ds_read_b128 a[64:67], v5 offset:0
    ds_read_b128 v[80:83], v6 offset:0
    ds_read_b128 v[84:87], v6 offset:1024
    s_waitcnt lgkmcnt(3)
    v_mfma_f32_32x32x16_bf16 v[16:31], v[92:95], a[60:63], v[16:31]
    s_add_u32 m0, s8, 57344
    s_nop 0
    buffer_load_dwordx4 v2, s[40:43], s9 offen lds
    s_add_u32 s9, s9, s11
    v_fmac_f32 v10, v76, v76
    v_sub_f32 v78, v78, v8
    v_fmac_f32 v10, v78, v78
    v_fmac_f32 v9, 1107296256, v10
    v_mfma_f32_32x32x16_bf16 v[32:47], v[96:99], a[60:63], v[32:47]
    v_mov_b32 v10, v9
    s_nop 1
    v_permlane32_swap_b32 v9, v10
    v_add_f32 v9, v9, v10
    v_mov_b32 v10, 925353388
    ds_read_b128 a[68:71], v5 offset:8192
    ds_read_b128 v[92:95], v6 offset:8192
    ds_read_b128 v[96:99], v6 offset:9216
    s_waitcnt lgkmcnt(3)
    v_mfma_f32_32x32x16_bf16 v[16:31], v[80:83], a[64:67], v[16:31]
    s_add_u32 m0, s8, 65536
    s_nop 0
    buffer_load_dwordx4 v2, s[40:43], s9 offen lds
    s_add_u32 s9, s9, s11
    v_fmac_f32 v10, 989855744, v9
    v_rsq_f32 v11, v10
    s_nop 0
    v_mul_f32 v12, v10, v11
    v_sub_f32 v13, 0, v8
    v_mfma_f32_32x32x16_bf16 v[32:47], v[84:87], a[64:67], v[32:47]
    s_add_u32 s13, s7, 229376
    s_add_u32 s14, s13, 4096
    buffer_load_dwordx4 v[108:111], v2, s[40:43], s14 offen
    s_add_u32 s14, s13, 5120
    buffer_load_dwordx4 v[112:115], v2, s[40:43], s14 offen
    s_add_u32 s14, s13, 6144
    buffer_load_dwordx4 v[124:127], v2, s[40:43], s14 offen
    v_cmp_eq_u32 vcc, 0, v3
    s_nop 1
    v_cndmask_b32 v13, v12, v13, vcc
    v_cvt_pk_bf16_f32 v14, v13, v13
    v_and_b32 v14, 4294901760, v14
    s_waitcnt vmcnt(8)
    s_barrier
    ds_read_b128 a[72:75], v5 offset:16384
    ds_read_b128 v[80:83], v6 offset:16384
    ds_read_b128 v[84:87], v6 offset:17408
    s_waitcnt lgkmcnt(3)
    v_mfma_f32_32x32x16_bf16 v[16:31], v[92:95], a[68:71], v[16:31]
    s_add_u32 m0, s8, 73728
    s_nop 0
    buffer_load_dwordx4 v2, s[40:43], s9 offen lds
    s_add_u32 s9, s9, s11
    v_sub_f32 v9, v13, v14
    v_cvt_pk_bf16_f32 v104, v14, v9
    v_mov_b32 v105, v104
    v_mov_b32 v106, 0
    v_mfma_f32_32x32x16_bf16 v[32:47], v[96:99], a[68:71], v[32:47]
    v_mov_b32 v107, 0
    v_mul_f32 v12, 3222493025, v11
    v_mul_f32 v13, v11, v11
    v_mul_f32 v13, v13, v11
    ds_read_b128 a[76:79], v5 offset:24576
    ds_read_b128 v[92:95], v6 offset:24576
    ds_read_b128 v[96:99], v6 offset:25600
    s_waitcnt lgkmcnt(3)
    v_mfma_f32_32x32x16_bf16 v[16:31], v[80:83], a[72:75], v[16:31]
    s_add_u32 m0, s8, 81920
    s_nop 0
    buffer_load_dwordx4 v2, s[40:43], s9 offen lds
    s_add_u32 s9, s9, s11
    v_mul_f32 v13, 3184710632, v13
    s_mul_i32 s60, s6, 114688
    s_mul_i32 s62, s5, 7168
    s_add_u32 s60, s60, s62
    v_mfma_f32_32x32x16_bf16 v[32:47], v[84:87], a[72:75], v[32:47]
    s_add_u32 s60, s60, 25169920
    s_waitcnt vmcnt(8)
    s_barrier
    ds_read_b128 a[80:83], v5 offset:32768
    ds_read_b128 v[80:83], v6 offset:32768
    ds_read_b128 v[84:87], v6 offset:33792
    s_waitcnt lgkmcnt(3)
    v_mfma_f32_32x32x16_bf16 v[16:31], v[92:95], a[76:79], v[16:31]
    s_add_u32 m0, s8, 90112
    s_nop 0
    buffer_load_dwordx4 v2, s[40:43], s9 offen lds
    s_add_u32 s9, s9, s11
    v_mfma_f32_32x32x16_bf16 v[32:47], v[96:99], a[76:79], v[32:47]
    ds_read_b128 a[84:87], v5 offset:40960
    ds_read_b128 v[92:95], v6 offset:40960
    ds_read_b128 v[96:99], v6 offset:41984
    s_waitcnt lgkmcnt(3)
    v_mfma_f32_32x32x16_bf16 v[16:31], v[80:83], a[80:83], v[16:31]
    s_add_u32 m0, s8, 98304
    s_nop 0
    buffer_load_dwordx4 v2, s[40:43], s9 offen lds
    s_add_u32 s9, s9, s11
    v_mfma_f32_32x32x16_bf16 v[32:47], v[84:87], a[80:83], v[32:47]
    s_waitcnt vmcnt(8)
    s_barrier
    ds_read_b128 a[88:91], v5 offset:49152
    ds_read_b128 v[80:83], v6 offset:49152
    ds_read_b128 v[84:87], v6 offset:50176
    s_waitcnt lgkmcnt(3)
    v_mfma_f32_32x32x16_bf16 v[16:31], v[92:95], a[84:87], v[16:31]
    s_add_u32 m0, s8, 106496
    s_nop 0
    buffer_load_dwordx4 v2, s[40:43], s9 offen lds
    s_add_u32 s9, s9, s11
    v_mfma_f32_32x32x16_bf16 v[32:47], v[96:99], a[84:87], v[32:47]
    ds_read_b128 a[92:95], v5 offset:57344
    ds_read_b128 v[92:95], v6 offset:57344
    ds_read_b128 v[96:99], v6 offset:58368
    s_waitcnt lgkmcnt(3)
    v_mfma_f32_32x32x16_bf16 v[16:31], v[80:83], a[88:91], v[16:31]
    s_add_u32 m0, s8, 114688
    s_nop 0
    buffer_load_dwordx4 v2, s[40:43], s9 offen lds
    s_add_u32 s9, s9, s11
    v_mfma_f32_32x32x16_bf16 v[32:47], v[84:87], a[88:91], v[32:47]
    s_waitcnt vmcnt(5)
    s_barrier
    ds_read_b128 a[96:99], v0 offset:0
    ds_read_b128 v[80:83], v1 offset:0
    ds_read_b128 v[84:87], v1 offset:1024
    s_waitcnt lgkmcnt(3)
    v_mfma_f32_32x32x16_bf16 v[16:31], v[92:95], a[92:95], v[16:31]
    s_add_u32 m0, s8, 122880
    s_nop 0
    buffer_load_dwordx4 v2, s[40:43], s9 offen lds
    s_add_u32 s9, s9, s11
    v_mfma_f32_32x32x16_bf16 v[32:47], v[96:99], a[92:95], v[32:47]
    ds_read_b128 a[100:103], v0 offset:8192
    ds_read_b128 v[92:95], v1 offset:8192
    ds_read_b128 v[96:99], v1 offset:9216
    s_waitcnt lgkmcnt(3)
    v_mfma_f32_32x32x16_bf16 v[16:31], v[80:83], a[96:99], v[16:31]
    v_mfma_f32_32x32x16_bf16 v[32:47], v[84:87], a[96:99], v[32:47]
    s_waitcnt vmcnt(4)
    s_barrier
    ds_read_b128 a[104:107], v0 offset:16384
    ds_read_b128 v[80:83], v1 offset:16384
    ds_read_b128 v[84:87], v1 offset:17408
    s_waitcnt lgkmcnt(3)
    v_mfma_f32_32x32x16_bf16 v[16:31], v[92:95], a[100:103], v[16:31]
    v_mfma_f32_32x32x16_bf16 v[32:47], v[96:99], a[100:103], v[32:47]
    ds_read_b128 a[108:111], v0 offset:24576
    ds_read_b128 v[92:95], v1 offset:24576
    ds_read_b128 v[96:99], v1 offset:25600
    s_waitcnt lgkmcnt(3)
    v_mfma_f32_32x32x16_bf16 v[16:31], v[80:83], a[104:107], v[16:31]
    s_add_u32 m0, s8, 0
    s_add_u32 s13, s12, 6144
    buffer_load_dwordx4 v2, s[40:43], s13 offen lds
    v_mfma_f32_32x32x16_bf16 v[32:47], v[84:87], a[104:107], v[32:47]
    s_waitcnt vmcnt(3)
    s_barrier
    ds_read_b128 a[112:115], v0 offset:32768
    ds_read_b128 v[80:83], v1 offset:32768
    ds_read_b128 v[84:87], v1 offset:33792
    s_waitcnt lgkmcnt(3)
    v_mfma_f32_32x32x16_bf16 v[16:31], v[92:95], a[108:111], v[16:31]
    s_add_u32 m0, s8, 8192
    s_add_u32 s13, s12, 63488
    buffer_load_dwordx4 v2, s[40:43], s13 offen lds
    v_mfma_f32_32x32x16_bf16 v[32:47], v[96:99], a[108:111], v[32:47]
    ds_read_b128 a[116:119], v0 offset:40960
    ds_read_b128 v[92:95], v1 offset:40960
    ds_read_b128 v[96:99], v1 offset:41984
    s_waitcnt lgkmcnt(3)
    v_mfma_f32_32x32x16_bf16 v[16:31], v[80:83], a[112:115], v[16:31]
    s_add_u32 m0, s8, 16384
    s_add_u32 s13, s12, 120832
    buffer_load_dwordx4 v2, s[40:43], s13 offen lds
    v_mfma_f32_32x32x16_bf16 v[32:47], v[84:87], a[112:115], v[32:47]
    s_waitcnt vmcnt(3)
    s_barrier
    ds_read_b128 a[120:123], v0 offset:49152
    ds_read_b128 v[80:83], v1 offset:49152
    ds_read_b128 v[84:87], v1 offset:50176
    s_waitcnt lgkmcnt(3)
    v_mfma_f32_32x32x16_bf16 v[16:31], v[92:95], a[116:119], v[16:31]
    s_add_u32 m0, s8, 24576
    s_add_u32 s13, s12, 178176
    buffer_load_dwordx4 v2, s[40:43], s13 offen lds
    v_mfma_f32_32x32x16_bf16 v[32:47], v[96:99], a[116:119], v[32:47]
    ds_read_b128 a[124:127], v0 offset:57344
    ds_read_b128 v[92:95], v1 offset:57344
    ds_read_b128 v[96:99], v1 offset:58368
    s_waitcnt lgkmcnt(3)
    v_mfma_f32_32x32x16_bf16 v[16:31], v[80:83], a[120:123], v[16:31]
    v_mfma_f32_32x32x16_bf16 v[32:47], v[84:87], a[120:123], v[32:47]
    s_waitcnt lgkmcnt(0)
    v_mfma_f32_32x32x16_bf16 v[16:31], v[92:95], a[124:127], v[16:31]
    v_mfma_f32_32x32x16_bf16 v[32:47], v[96:99], a[124:127], v[32:47]
    s_waitcnt vmcnt(11)
    v_mfma_f32_32x32x16_bf16 v[16:31], v[108:111], v[104:107], v[16:31]
    v_mfma_f32_32x32x16_bf16 v[32:47], v[112:115], v[104:107], v[32:47]
    s_add_u32 m0, s8, 32768
    s_add_u32 s13, s12, 3072
    buffer_load_dwordx4 v2, s[40:43], s13 offen lds
    s_add_u32 m0, s8, 40960
    s_add_u32 s13, s12, 60416
    buffer_load_dwordx4 v2, s[40:43], s13 offen lds
    s_add_u32 m0, s8, 49152
    s_add_u32 s13, s12, 117760
    buffer_load_dwordx4 v2, s[40:43], s13 offen lds
    s_add_u32 m0, s8, 57344
    s_add_u32 s13, s12, 175104
    buffer_load_dwordx4 v2, s[40:43], s13 offen lds
    s_waitcnt vmcnt(4)
    s_barrier
    ds_read_b128 v[80:83], v15 offset:0
    ds_read_b128 v[84:87], v15 offset:1024
    ds_read_b128 v[88:91], v15 offset:2048
    ds_read_b128 v[92:95], v15 offset:3072
    ds_read_b128 v[96:99], v15 offset:4096
    v_mfma_f32_32x32x16_bf16 v[48:63], v[124:127], v[104:107], 0
    ds_read_b128 v[100:103], v15 offset:5120
    s_waitcnt lgkmcnt(5)
    v_mfma_f32_32x32x16_bf16 v[48:63], v[80:83], a[0:3], v[48:63]
    ds_read_b128 v[80:83], v15 offset:6144
    s_waitcnt lgkmcnt(5)
    v_mfma_f32_32x32x16_bf16 v[48:63], v[84:87], a[4:7], v[48:63]
    ds_read_b128 v[84:87], v15 offset:7168
    s_waitcnt lgkmcnt(5)
    v_mfma_f32_32x32x16_bf16 v[48:63], v[88:91], a[8:11], v[48:63]
    ds_read_b128 v[88:91], v15 offset:8192
    s_waitcnt lgkmcnt(5)
    v_mfma_f32_32x32x16_bf16 v[48:63], v[92:95], a[12:15], v[48:63]
    ds_read_b128 v[92:95], v15 offset:9216
    s_waitcnt lgkmcnt(5)
    v_mfma_f32_32x32x16_bf16 v[48:63], v[96:99], a[16:19], v[48:63]
    ds_read_b128 v[96:99], v15 offset:10240
    s_waitcnt lgkmcnt(5)
    v_mfma_f32_32x32x16_bf16 v[48:63], v[100:103], a[20:23], v[48:63]
    ds_read_b128 v[100:103], v15 offset:11264
    s_waitcnt lgkmcnt(5)
    v_mfma_f32_32x32x16_bf16 v[48:63], v[80:83], a[24:27], v[48:63]
    ds_read_b128 v[80:83], v15 offset:12288
    s_waitcnt lgkmcnt(5)
    v_mfma_f32_32x32x16_bf16 v[48:63], v[84:87], a[28:31], v[48:63]
    ds_read_b128 v[84:87], v15 offset:13312
    s_waitcnt lgkmcnt(5)
    v_mfma_f32_32x32x16_bf16 v[48:63], v[88:91], a[32:35], v[48:63]
    ds_read_b128 v[88:91], v15 offset:14336
    s_waitcnt lgkmcnt(5)
    v_mfma_f32_32x32x16_bf16 v[48:63], v[92:95], a[36:39], v[48:63]
    ds_read_b128 v[92:95], v15 offset:15360
    s_waitcnt lgkmcnt(5)
    v_mfma_f32_32x32x16_bf16 v[48:63], v[96:99], a[40:43], v[48:63]
    ds_read_b128 v[96:99], v15 offset:16384
    s_waitcnt lgkmcnt(5)
    v_mfma_f32_32x32x16_bf16 v[48:63], v[100:103], a[44:47], v[48:63]
    ds_read_b128 v[100:103], v15 offset:17408
    s_waitcnt lgkmcnt(5)
    v_mfma_f32_32x32x16_bf16 v[48:63], v[80:83], a[48:51], v[48:63]
    ds_read_b128 v[80:83], v15 offset:18432
    s_waitcnt lgkmcnt(5)
    v_mfma_f32_32x32x16_bf16 v[48:63], v[84:87], a[52:55], v[48:63]
    ds_read_b128 v[84:87], v15 offset:19456
    s_waitcnt lgkmcnt(5)
    v_mfma_f32_32x32x16_bf16 v[48:63], v[88:91], a[56:59], v[48:63]
    ds_read_b128 v[88:91], v15 offset:20480
    s_waitcnt lgkmcnt(5)
    v_mfma_f32_32x32x16_bf16 v[48:63], v[92:95], a[60:63], v[48:63]
    ds_read_b128 v[92:95], v15 offset:21504
    s_waitcnt lgkmcnt(5)
    v_mfma_f32_32x32x16_bf16 v[48:63], v[96:99], a[64:67], v[48:63]
    ds_read_b128 v[96:99], v15 offset:22528
    s_waitcnt lgkmcnt(5)
    v_mfma_f32_32x32x16_bf16 v[48:63], v[100:103], a[68:71], v[48:63]
    ds_read_b128 v[100:103], v15 offset:23552
    s_waitcnt lgkmcnt(5)
    v_mfma_f32_32x32x16_bf16 v[48:63], v[80:83], a[72:75], v[48:63]
    ds_read_b128 v[80:83], v15 offset:24576
    s_waitcnt lgkmcnt(5)
    v_mfma_f32_32x32x16_bf16 v[48:63], v[84:87], a[76:79], v[48:63]
    ds_read_b128 v[84:87], v15 offset:25600
    s_waitcnt lgkmcnt(5)
    v_mfma_f32_32x32x16_bf16 v[48:63], v[88:91], a[80:83], v[48:63]
    ds_read_b128 v[88:91], v15 offset:26624
    s_waitcnt lgkmcnt(5)
    v_mfma_f32_32x32x16_bf16 v[48:63], v[92:95], a[84:87], v[48:63]
    ds_read_b128 v[92:95], v15 offset:27648
    s_waitcnt lgkmcnt(5)
    v_mfma_f32_32x32x16_bf16 v[48:63], v[96:99], a[88:91], v[48:63]
    ds_read_b128 v[96:99], v15 offset:28672
    s_waitcnt lgkmcnt(5)
    v_mfma_f32_32x32x16_bf16 v[48:63], v[100:103], a[92:95], v[48:63]
    ds_read_b128 v[100:103], v15 offset:29696
    s_waitcnt lgkmcnt(5)
    v_mfma_f32_32x32x16_bf16 v[48:63], v[80:83], a[96:99], v[48:63]
    ds_read_b128 v[80:83], v15 offset:30720
    s_waitcnt lgkmcnt(5)
    v_mfma_f32_32x32x16_bf16 v[48:63], v[84:87], a[100:103], v[48:63]
    ds_read_b128 v[84:87], v15 offset:31744
    s_waitcnt lgkmcnt(5)
    v_mfma_f32_32x32x16_bf16 v[48:63], v[88:91], a[104:107], v[48:63]
    s_waitcnt lgkmcnt(4)
    v_mfma_f32_32x32x16_bf16 v[48:63], v[92:95], a[108:111], v[48:63]
    s_waitcnt lgkmcnt(3)
    v_mfma_f32_32x32x16_bf16 v[48:63], v[96:99], a[112:115], v[48:63]
    s_waitcnt lgkmcnt(2)
    v_mfma_f32_32x32x16_bf16 v[48:63], v[100:103], a[116:119], v[48:63]
    s_waitcnt lgkmcnt(1)
    v_mfma_f32_32x32x16_bf16 v[48:63], v[80:83], a[120:123], v[48:63]
    s_waitcnt lgkmcnt(0)
    v_mfma_f32_32x32x16_bf16 v[48:63], v[84:87], a[124:127], v[48:63]
    s_waitcnt vmcnt(0)
    s_barrier
    v_mul_f32 v108, v16, v16
    v_mul_f32 v109, v17, v17
    v_mul_f32 v110, v18, v18
    v_mul_f32 v111, v19, v19
    v_mul_f32 v112, v20, v20
    v_mul_f32 v113, v21, v21
    v_mul_f32 v114, v22, v22
    v_mul_f32 v115, v23, v23
    v_fma_f32 v108, v108, v13, v12
    v_fma_f32 v109, v109, v13, v12
    v_fma_f32 v110, v110, v13, v12
    v_fma_f32 v111, v111, v13, v12
    v_fma_f32 v112, v112, v13, v12
    v_fma_f32 v113, v113, v13, v12
    v_fma_f32 v114, v114, v13, v12
    v_fma_f32 v115, v115, v13, v12
    v_mul_f32 v108, v108, v16
    v_mul_f32 v109, v109, v17
    v_mul_f32 v110, v110, v18
    v_mul_f32 v111, v111, v19
    v_mul_f32 v112, v112, v20
    v_mul_f32 v113, v113, v21
    v_mul_f32 v114, v114, v22
    v_mul_f32 v115, v115, v23
    v_exp_f32 v108, v108
    v_exp_f32 v109, v109
    v_exp_f32 v110, v110
    v_exp_f32 v111, v111
    v_exp_f32 v112, v112
    v_exp_f32 v113, v113
    v_exp_f32 v114, v114
    v_exp_f32 v115, v115
    v_mul_f32 v24, v24, v16
    v_mul_f32 v25, v25, v17
    v_mul_f32 v26, v26, v18
    v_mul_f32 v27, v27, v19
    v_mul_f32 v28, v28, v20
    v_mul_f32 v29, v29, v21
    v_mul_f32 v30, v30, v22
    v_mul_f32 v31, v31, v23
    v_fma_f32 v108, v108, v10, v10
    v_fma_f32 v109, v109, v10, v10
    v_fma_f32 v110, v110, v10, v10
    v_fma_f32 v111, v111, v10, v10
    v_fma_f32 v112, v112, v10, v10
    v_fma_f32 v113, v113, v10, v10
    v_fma_f32 v114, v114, v10, v10
    v_fma_f32 v115, v115, v10, v10
    v_rcp_f32 v108, v108
    v_rcp_f32 v109, v109
    v_rcp_f32 v110, v110
    v_rcp_f32 v111, v111
    v_rcp_f32 v112, v112
    v_rcp_f32 v113, v113
    v_rcp_f32 v114, v114
    v_rcp_f32 v115, v115
    v_mul_f32 v108, v108, v24
    v_mul_f32 v109, v109, v25
    v_mul_f32 v110, v110, v26
    v_mul_f32 v111, v111, v27
    v_mul_f32 v112, v112, v28
    v_mul_f32 v113, v113, v29
    v_mul_f32 v114, v114, v30
    v_mul_f32 v115, v115, v31
    v_cvt_pk_bf16_f32 v116, v108, v109
    v_cvt_pk_bf16_f32 v117, v110, v111
    v_cvt_pk_bf16_f32 v118, v112, v113
    v_cvt_pk_bf16_f32 v119, v114, v115
    buffer_store_dwordx4 v[116:119], v2, s[40:43], s60 offen offset:0 sc1
    v_mul_f32 v108, v32, v32
    v_mul_f32 v109, v33, v33
    v_mul_f32 v110, v34, v34
    v_mul_f32 v111, v35, v35
    v_mul_f32 v112, v36, v36
    v_mul_f32 v113, v37, v37
    v_mul_f32 v114, v38, v38
    v_mul_f32 v115, v39, v39
    v_fma_f32 v108, v108, v13, v12
    v_fma_f32 v109, v109, v13, v12
    v_fma_f32 v110, v110, v13, v12
    v_fma_f32 v111, v111, v13, v12
    v_fma_f32 v112, v112, v13, v12
    v_fma_f32 v113, v113, v13, v12
    v_fma_f32 v114, v114, v13, v12
    v_fma_f32 v115, v115, v13, v12
    v_mul_f32 v108, v108, v32
    v_mul_f32 v109, v109, v33
    v_mul_f32 v110, v110, v34
    v_mul_f32 v111, v111, v35
    v_mul_f32 v112, v112, v36
    v_mul_f32 v113, v113, v37
    v_mul_f32 v114, v114, v38
    v_mul_f32 v115, v115, v39
    v_exp_f32 v108, v108
    v_exp_f32 v109, v109
    v_exp_f32 v110, v110
    v_exp_f32 v111, v111
    v_exp_f32 v112, v112
    v_exp_f32 v113, v113
    v_exp_f32 v114, v114
    v_exp_f32 v115, v115
    v_mul_f32 v40, v40, v32
    v_mul_f32 v41, v41, v33
    v_mul_f32 v42, v42, v34
    v_mul_f32 v43, v43, v35
    v_mul_f32 v44, v44, v36
    v_mul_f32 v45, v45, v37
    v_mul_f32 v46, v46, v38
    v_mul_f32 v47, v47, v39
    v_fma_f32 v108, v108, v10, v10
    v_fma_f32 v109, v109, v10, v10
    v_fma_f32 v110, v110, v10, v10
    v_fma_f32 v111, v111, v10, v10
    v_fma_f32 v112, v112, v10, v10
    v_fma_f32 v113, v113, v10, v10
    v_fma_f32 v114, v114, v10, v10
    v_fma_f32 v115, v115, v10, v10
    v_rcp_f32 v108, v108
    v_rcp_f32 v109, v109
    v_rcp_f32 v110, v110
    v_rcp_f32 v111, v111
    v_rcp_f32 v112, v112
    v_rcp_f32 v113, v113
    v_rcp_f32 v114, v114
    v_rcp_f32 v115, v115
    v_mul_f32 v108, v108, v40
    v_mul_f32 v109, v109, v41
    v_mul_f32 v110, v110, v42
    v_mul_f32 v111, v111, v43
    v_mul_f32 v112, v112, v44
    v_mul_f32 v113, v113, v45
    v_mul_f32 v114, v114, v46
    v_mul_f32 v115, v115, v47
    v_cvt_pk_bf16_f32 v120, v108, v109
    v_cvt_pk_bf16_f32 v121, v110, v111
    v_cvt_pk_bf16_f32 v122, v112, v113
    v_cvt_pk_bf16_f32 v123, v114, v115
    buffer_store_dwordx4 v[120:123], v2, s[40:43], s60 offen offset:1024 sc1
    v_mul_f32 v108, v48, v48
    v_mul_f32 v109, v49, v49
    v_mul_f32 v110, v50, v50
    v_mul_f32 v111, v51, v51
    v_mul_f32 v112, v52, v52
    v_mul_f32 v113, v53, v53
    v_mul_f32 v114, v54, v54
    v_mul_f32 v115, v55, v55
    v_fma_f32 v108, v108, v13, v12
    v_fma_f32 v109, v109, v13, v12
    v_fma_f32 v110, v110, v13, v12
    v_fma_f32 v111, v111, v13, v12
    v_fma_f32 v112, v112, v13, v12
    v_fma_f32 v113, v113, v13, v12
    v_fma_f32 v114, v114, v13, v12
    v_fma_f32 v115, v115, v13, v12
    v_mul_f32 v108, v108, v48
    v_mul_f32 v109, v109, v49
    v_mul_f32 v110, v110, v50
    v_mul_f32 v111, v111, v51
    v_mul_f32 v112, v112, v52
    v_mul_f32 v113, v113, v53
    v_mul_f32 v114, v114, v54
    v_mul_f32 v115, v115, v55
    v_exp_f32 v108, v108
    v_exp_f32 v109, v109
    v_exp_f32 v110, v110
    v_exp_f32 v111, v111
    v_exp_f32 v112, v112
    v_exp_f32 v113, v113
    v_exp_f32 v114, v114
    v_exp_f32 v115, v115
    v_mul_f32 v56, v56, v48
    v_mul_f32 v57, v57, v49
    v_mul_f32 v58, v58, v50
    v_mul_f32 v59, v59, v51
    v_mul_f32 v60, v60, v52
    v_mul_f32 v61, v61, v53
    v_mul_f32 v62, v62, v54
    v_mul_f32 v63, v63, v55
    v_fma_f32 v108, v108, v10, v10
    v_fma_f32 v109, v109, v10, v10
    v_fma_f32 v110, v110, v10, v10
    v_fma_f32 v111, v111, v10, v10
    v_fma_f32 v112, v112, v10, v10
    v_fma_f32 v113, v113, v10, v10
    v_fma_f32 v114, v114, v10, v10
    v_fma_f32 v115, v115, v10, v10
    v_rcp_f32 v108, v108
    v_rcp_f32 v109, v109
    v_rcp_f32 v110, v110
    v_rcp_f32 v111, v111
    v_rcp_f32 v112, v112
    v_rcp_f32 v113, v113
    v_rcp_f32 v114, v114
    v_rcp_f32 v115, v115
    v_mul_f32 v108, v108, v56
    v_mul_f32 v109, v109, v57
    v_mul_f32 v110, v110, v58
    v_mul_f32 v111, v111, v59
    v_mul_f32 v112, v112, v60
    v_mul_f32 v113, v113, v61
    v_mul_f32 v114, v114, v62
    v_mul_f32 v115, v115, v63
    v_cvt_pk_bf16_f32 v116, v108, v109
    v_cvt_pk_bf16_f32 v117, v110, v111
    v_cvt_pk_bf16_f32 v118, v112, v113
    v_cvt_pk_bf16_f32 v119, v114, v115
    buffer_store_dwordx4 v[116:119], v2, s[40:43], s60 offen offset:2048 sc1
    s_nop 1
L_k4_done:
L_end_k4_ffn1_kernel:
    s_endpgm

.globl k5_down_kernel
.p2align 8
.type k5_down_kernel,@function
k5_down_kernel:
    s_cmp_ge_u32 s2, 256
    s_cbranch_scc1 L_end_k5_down_kernel
    s_load_dwordx8 s[32:39], s[0:1], 64
    v_and_b32 v1, 63, v0
    v_lshrrev_b32 v2, 6, v0
    s_nop 0
    v_readfirstlane_b32 s3, v2
    s_bfe_u32 s4, s2, 131073
    s_lshl_b32 s4, s4, 3
    s_bfe_u32 s5, s2, 196611
    s_add_u32 s4, s4, s5
    s_and_b32 s5, s2, 1
    s_lshl_b32 s5, s5, 2
    s_lshr_b32 s62, s2, 6
    s_add_u32 s5, s5, s62
    v_lshlrev_b32 v2, 4, v1
    v_lshrrev_b32 v3, 5, v1
    v_and_b32 v4, 31, v1
    s_lshr_b32 s6, s2, 3
    s_mul_i32 s6, s6, 0
    s_lshr_b32 s6, s6, 5
    s_mul_i32 s61, s3, 28
    s_add_u32 s6, s6, s61
    s_cmp_ge_u32 s6, 112
    s_cselect_b32 s61, 112, 0
    s_sub_u32 s6, s6, s61
    s_lshl_b32 s6, s6, 10
    s_and_b32 s11, s3, 1
    s_lshr_b32 s12, s3, 1
    s_lshl_b32 s13, s4, 1
    s_add_u32 s13, s13, s12
    s_lshl_b32 s14, s5, 1
    s_add_u32 s14, s14, s11
    s_mul_i32 s7, s13, 114688
    s_add_u32 s7, s7, 25165824
    s_xor_b32 s8, s13, 1
    s_mul_i32 s8, s8, 114688
    s_add_u32 s8, s8, 25165824
    s_mul_i32 s9, s14, 114688
    s_add_u32 s9, s9, 17301504
    s_xor_b32 s10, s14, 1
    s_mul_i32 s10, s10, 114688
    s_add_u32 s10, s10, 17301504
    s_waitcnt lgkmcnt(0)
    s_mov_b32 s40, s38
    s_mov_b32 s41, s39
    s_mov_b32 s42, 34603008
    s_mov_b32 s43, 131072
    v_add_u32 v12, s6, v2
    s_add_u32 s6, s6, 1024
    s_cmp_eq_u32 s6, 114688
    s_cselect_b32 s6, 0, s6
    buffer_load_dwordx4 v[104:107], v12, s[40:43], s9 offen
    buffer_load_dwordx4 v[108:111], v12, s[40:43], s7 offen
    buffer_load_dwordx4 v[112:115], v12, s[40:43], s10 offen
    buffer_load_dwordx4 v[116:119], v12, s[40:43], s8 offen
    v_add_u32 v11, s6, v2
    s_add_u32 s6, s6, 1024
    s_cmp_eq_u32 s6, 114688
    s_cselect_b32 s6, 0, s6
    buffer_load_dwordx4 v[120:123], v11, s[40:43], s9 offen
    buffer_load_dwordx4 v[124:127], v11, s[40:43], s7 offen
    buffer_load_dwordx4 v[128:131], v11, s[40:43], s10 offen
    buffer_load_dwordx4 v[132:135], v11, s[40:43], s8 offen
    v_add_u32 v12, s6, v2
    s_add_u32 s6, s6, 1024
    s_cmp_eq_u32 s6, 114688
    s_cselect_b32 s6, 0, s6
    buffer_load_dwordx4 v[136:139], v12, s[40:43], s9 offen
    buffer_load_dwordx4 v[140:143], v12, s[40:43], s7 offen
    buffer_load_dwordx4 v[144:147], v12, s[40:43], s10 offen
    buffer_load_dwordx4 v[148:151], v12, s[40:43], s8 offen
    v_add_u32 v11, s6, v2
    s_add_u32 s6, s6, 1024
    s_cmp_eq_u32 s6, 114688
    s_cselect_b32 s6, 0, s6
    buffer_load_dwordx4 v[152:155], v11, s[40:43], s9 offen
    buffer_load_dwordx4 v[156:159], v11, s[40:43], s7 offen
    buffer_load_dwordx4 v[160:163], v11, s[40:43], s10 offen
    buffer_load_dwordx4 v[164:167], v11, s[40:43], s8 offen
    v_add_u32 v12, s6, v2
    s_add_u32 s6, s6, 1024
    s_cmp_eq_u32 s6, 114688
    s_cselect_b32 s6, 0, s6
    buffer_load_dwordx4 v[168:171], v12, s[40:43], s9 offen
    buffer_load_dwordx4 v[172:175], v12, s[40:43], s7 offen
    buffer_load_dwordx4 v[176:179], v12, s[40:43], s10 offen
    buffer_load_dwordx4 v[180:183], v12, s[40:43], s8 offen
    v_add_u32 v11, s6, v2
    s_add_u32 s6, s6, 1024
    s_cmp_eq_u32 s6, 114688
    s_cselect_b32 s6, 0, s6
    buffer_load_dwordx4 v[184:187], v11, s[40:43], s9 offen
    buffer_load_dwordx4 v[188:191], v11, s[40:43], s7 offen
    buffer_load_dwordx4 v[192:195], v11, s[40:43], s10 offen
    buffer_load_dwordx4 v[196:199], v11, s[40:43], s8 offen
    s_waitcnt vmcnt(20)
    v_mfma_f32_32x32x16_bf16 v[32:47], v[104:107], v[116:119], 0
    v_mfma_f32_32x32x16_bf16 v[48:63], v[112:115], v[108:111], 0
    v_mfma_f32_32x32x16_bf16 v[64:79], v[112:115], v[116:119], 0
    v_mfma_f32_32x32x16_bf16 v[16:31], v[104:107], v[108:111], 0
    v_add_u32 v12, s6, v2
    s_add_u32 s6, s6, 1024
    s_cmp_eq_u32 s6, 114688
    s_cselect_b32 s6, 0, s6
    buffer_load_dwordx4 v[200:203], v12, s[40:43], s9 offen
    buffer_load_dwordx4 v[204:207], v12, s[40:43], s7 offen
    buffer_load_dwordx4 v[208:211], v12, s[40:43], s10 offen
    buffer_load_dwordx4 v[212:215], v12, s[40:43], s8 offen
    v_add_u32 v11, s6, v2
    s_add_u32 s6, s6, 1024
    s_cmp_eq_u32 s6, 114688
    s_cselect_b32 s6, 0, s6
    buffer_load_dwordx4 v[216:219], v11, s[40:43], s9 offen
    buffer_load_dwordx4 v[220:223], v11, s[40:43], s7 offen
    buffer_load_dwordx4 v[224:227], v11, s[40:43], s10 offen
    buffer_load_dwordx4 v[228:231], v11, s[40:43], s8 offen
    s_waitcnt vmcnt(24)
    v_mfma_f32_32x32x16_bf16 v[32:47], v[120:123], v[132:135], v[32:47]
    v_mfma_f32_32x32x16_bf16 v[48:63], v[128:131], v[124:127], v[48:63]
    v_mfma_f32_32x32x16_bf16 v[64:79], v[128:131], v[132:135], v[64:79]
    v_mfma_f32_32x32x16_bf16 v[16:31], v[120:123], v[124:127], v[16:31]
    v_add_u32 v12, s6, v2
    s_add_u32 s6, s6, 1024
    s_cmp_eq_u32 s6, 114688
    s_cselect_b32 s6, 0, s6
    buffer_load_dwordx4 v[104:107], v12, s[40:43], s9 offen
    buffer_load_dwordx4 v[108:111], v12, s[40:43], s7 offen
    buffer_load_dwordx4 v[112:115], v12, s[40:43], s10 offen
    buffer_load_dwordx4 v[116:119], v12, s[40:43], s8 offen
    v_add_u32 v11, s6, v2
    s_add_u32 s6, s6, 1024
    s_cmp_eq_u32 s6, 114688
    s_cselect_b32 s6, 0, s6
    buffer_load_dwordx4 v[120:123], v11, s[40:43], s9 offen
    buffer_load_dwordx4 v[124:127], v11, s[40:43], s7 offen
    buffer_load_dwordx4 v[128:131], v11, s[40:43], s10 offen
    buffer_load_dwordx4 v[132:135], v11, s[40:43], s8 offen
    s_waitcnt vmcnt(28)
    v_mfma_f32_32x32x16_bf16 v[32:47], v[136:139], v[148:151], v[32:47]
    v_mfma_f32_32x32x16_bf16 v[48:63], v[144:147], v[140:143], v[48:63]
    v_mfma_f32_32x32x16_bf16 v[64:79], v[144:147], v[148:151], v[64:79]
    v_mfma_f32_32x32x16_bf16 v[16:31], v[136:139], v[140:143], v[16:31]
    v_add_u32 v12, s6, v2
    s_add_u32 s6, s6, 1024
    s_cmp_eq_u32 s6, 114688
    s_cselect_b32 s6, 0, s6
    buffer_load_dwordx4 v[136:139], v12, s[40:43], s9 offen
    buffer_load_dwordx4 v[140:143], v12, s[40:43], s7 offen
    buffer_load_dwordx4 v[144:147], v12, s[40:43], s10 offen
    buffer_load_dwordx4 v[148:151], v12, s[40:43], s8 offen
    s_waitcnt vmcnt(28)
    v_mfma_f32_32x32x16_bf16 v[32:47], v[152:155], v[164:167], v[32:47]
    v_mfma_f32_32x32x16_bf16 v[48:63], v[160:163], v[156:159], v[48:63]
    v_mfma_f32_32x32x16_bf16 v[64:79], v[160:163], v[164:167], v[64:79]
    v_mfma_f32_32x32x16_bf16 v[16:31], v[152:155], v[156:159], v[16:31]
    v_add_u32 v11, s6, v2
    s_add_u32 s6, s6, 1024
    s_cmp_eq_u32 s6, 114688
    s_cselect_b32 s6, 0, s6
    buffer_load_dwordx4 v[152:155], v11, s[40:43], s9 offen
    buffer_load_dwordx4 v[156:159], v11, s[40:43], s7 offen
    buffer_load_dwordx4 v[160:163], v11, s[40:43], s10 offen
    buffer_load_dwordx4 v[164:167], v11, s[40:43], s8 offen
    s_waitcnt vmcnt(28)
    v_mfma_f32_32x32x16_bf16 v[32:47], v[168:171], v[180:183], v[32:47]
    v_mfma_f32_32x32x16_bf16 v[48:63], v[176:179], v[172:175], v[48:63]
    v_mfma_f32_32x32x16_bf16 v[64:79], v[176:179], v[180:183], v[64:79]
    v_mfma_f32_32x32x16_bf16 v[16:31], v[168:171], v[172:175], v[16:31]
    v_add_u32 v12, s6, v2
    s_add_u32 s6, s6, 1024
    s_cmp_eq_u32 s6, 114688
    s_cselect_b32 s6, 0, s6
    buffer_load_dwordx4 v[168:171], v12, s[40:43], s9 offen
    buffer_load_dwordx4 v[172:175], v12, s[40:43], s7 offen
    buffer_load_dwordx4 v[176:179], v12, s[40:43], s10 offen
    buffer_load_dwordx4 v[180:183], v12, s[40:43], s8 offen
    s_waitcnt vmcnt(28)
    v_mfma_f32_32x32x16_bf16 v[32:47], v[184:187], v[196:199], v[32:47]
    v_mfma_f32_32x32x16_bf16 v[48:63], v[192:195], v[188:191], v[48:63]
    v_mfma_f32_32x32x16_bf16 v[64:79], v[192:195], v[196:199], v[64:79]
    v_mfma_f32_32x32x16_bf16 v[16:31], v[184:187], v[188:191], v[16:31]
    v_add_u32 v11, s6, v2
    s_add_u32 s6, s6, 1024
    s_cmp_eq_u32 s6, 114688
    s_cselect_b32 s6, 0, s6
    buffer_load_dwordx4 v[184:187], v11, s[40:43], s9 offen
    buffer_load_dwordx4 v[188:191], v11, s[40:43], s7 offen
    buffer_load_dwordx4 v[192:195], v11, s[40:43], s10 offen
    buffer_load_dwordx4 v[196:199], v11, s[40:43], s8 offen
    s_waitcnt vmcnt(28)
    v_mfma_f32_32x32x16_bf16 v[32:47], v[200:203], v[212:215], v[32:47]
    v_mfma_f32_32x32x16_bf16 v[48:63], v[208:211], v[204:207], v[48:63]
    v_mfma_f32_32x32x16_bf16 v[64:79], v[208:211], v[212:215], v[64:79]
    v_mfma_f32_32x32x16_bf16 v[16:31], v[200:203], v[204:207], v[16:31]
    v_add_u32 v12, s6, v2
    s_add_u32 s6, s6, 1024
    s_cmp_eq_u32 s6, 114688
    s_cselect_b32 s6, 0, s6
    buffer_load_dwordx4 v[200:203], v12, s[40:43], s9 offen
    buffer_load_dwordx4 v[204:207], v12, s[40:43], s7 offen
    buffer_load_dwordx4 v[208:211], v12, s[40:43], s10 offen
    buffer_load_dwordx4 v[212:215], v12, s[40:43], s8 offen
    s_waitcnt vmcnt(28)
    v_mfma_f32_32x32x16_bf16 v[32:47], v[216:219], v[228:231], v[32:47]
    v_mfma_f32_32x32x16_bf16 v[48:63], v[224:227], v[220:223], v[48:63]
    v_mfma_f32_32x32x16_bf16 v[64:79], v[224:227], v[228:231], v[64:79]
    v_mfma_f32_32x32x16_bf16 v[16:31], v[216:219], v[220:223], v[16:31]
    v_add_u32 v11, s6, v2
    s_add_u32 s6, s6, 1024
    s_cmp_eq_u32 s6, 114688
    s_cselect_b32 s6, 0, s6
    buffer_load_dwordx4 v[216:219], v11, s[40:43], s9 offen
    buffer_load_dwordx4 v[220:223], v11, s[40:43], s7 offen
    buffer_load_dwordx4 v[224:227], v11, s[40:43], s10 offen
    buffer_load_dwordx4 v[228:231], v11, s[40:43], s8 offen
    s_waitcnt vmcnt(28)
    v_mfma_f32_32x32x16_bf16 v[32:47], v[104:107], v[116:119], v[32:47]
    v_mfma_f32_32x32x16_bf16 v[48:63], v[112:115], v[108:111], v[48:63]
    v_mfma_f32_32x32x16_bf16 v[64:79], v[112:115], v[116:119], v[64:79]
    v_mfma_f32_32x32x16_bf16 v[16:31], v[104:107], v[108:111], v[16:31]
    v_add_u32 v12, s6, v2
    s_add_u32 s6, s6, 1024
    s_cmp_eq_u32 s6, 114688
    s_cselect_b32 s6, 0, s6
    buffer_load_dwordx4 v[104:107], v12, s[40:43], s9 offen
    buffer_load_dwordx4 v[108:111], v12, s[40:43], s7 offen
    buffer_load_dwordx4 v[112:115], v12, s[40:43], s10 offen
    buffer_load_dwordx4 v[116:119], v12, s[40:43], s8 offen
    s_waitcnt vmcnt(28)
    v_mfma_f32_32x32x16_bf16 v[32:47], v[120:123], v[132:135], v[32:47]
    v_mfma_f32_32x32x16_bf16 v[48:63], v[128:131], v[124:127], v[48:63]
    v_mfma_f32_32x32x16_bf16 v[64:79], v[128:131], v[132:135], v[64:79]
    v_mfma_f32_32x32x16_bf16 v[16:31], v[120:123], v[124:127], v[16:31]
    v_add_u32 v11, s6, v2
    s_add_u32 s6, s6, 1024
    s_cmp_eq_u32 s6, 114688
    s_cselect_b32 s6, 0, s6
    buffer_load_dwordx4 v[120:123], v11, s[40:43], s9 offen
    buffer_load_dwordx4 v[124:127], v11, s[40:43], s7 offen
    buffer_load_dwordx4 v[128:131], v11, s[40:43], s10 offen
    buffer_load_dwordx4 v[132:135], v11, s[40:43], s8 offen
    s_waitcnt vmcnt(28)
    v_mfma_f32_32x32x16_bf16 v[32:47], v[136:139], v[148:151], v[32:47]
    v_mfma_f32_32x32x16_bf16 v[48:63], v[144:147], v[140:143], v[48:63]
    v_mfma_f32_32x32x16_bf16 v[64:79], v[144:147], v[148:151], v[64:79]
    v_mfma_f32_32x32x16_bf16 v[16:31], v[136:139], v[140:143], v[16:31]
    v_add_u32 v12, s6, v2
    s_add_u32 s6, s6, 1024
    s_cmp_eq_u32 s6, 114688
    s_cselect_b32 s6, 0, s6
    buffer_load_dwordx4 v[136:139], v12, s[40:43], s9 offen
    buffer_load_dwordx4 v[140:143], v12, s[40:43], s7 offen
    buffer_load_dwordx4 v[144:147], v12, s[40:43], s10 offen
    buffer_load_dwordx4 v[148:151], v12, s[40:43], s8 offen
    s_waitcnt vmcnt(28)
    v_mfma_f32_32x32x16_bf16 v[32:47], v[152:155], v[164:167], v[32:47]
    v_mfma_f32_32x32x16_bf16 v[48:63], v[160:163], v[156:159], v[48:63]
    v_mfma_f32_32x32x16_bf16 v[64:79], v[160:163], v[164:167], v[64:79]
    v_mfma_f32_32x32x16_bf16 v[16:31], v[152:155], v[156:159], v[16:31]
    v_add_u32 v11, s6, v2
    s_add_u32 s6, s6, 1024
    s_cmp_eq_u32 s6, 114688
    s_cselect_b32 s6, 0, s6
    buffer_load_dwordx4 v[152:155], v11, s[40:43], s9 offen
    buffer_load_dwordx4 v[156:159], v11, s[40:43], s7 offen
    buffer_load_dwordx4 v[160:163], v11, s[40:43], s10 offen
    buffer_load_dwordx4 v[164:167], v11, s[40:43], s8 offen
    s_waitcnt vmcnt(28)
    v_mfma_f32_32x32x16_bf16 v[32:47], v[168:171], v[180:183], v[32:47]
    v_mfma_f32_32x32x16_bf16 v[48:63], v[176:179], v[172:175], v[48:63]
    v_mfma_f32_32x32x16_bf16 v[64:79], v[176:179], v[180:183], v[64:79]
    v_mfma_f32_32x32x16_bf16 v[16:31], v[168:171], v[172:175], v[16:31]
    v_add_u32 v12, s6, v2
    s_add_u32 s6, s6, 1024
    s_cmp_eq_u32 s6, 114688
    s_cselect_b32 s6, 0, s6
    buffer_load_dwordx4 v[168:171], v12, s[40:43], s9 offen
    buffer_load_dwordx4 v[172:175], v12, s[40:43], s7 offen
    buffer_load_dwordx4 v[176:179], v12, s[40:43], s10 offen
    buffer_load_dwordx4 v[180:183], v12, s[40:43], s8 offen
    s_waitcnt vmcnt(28)
    v_mfma_f32_32x32x16_bf16 v[32:47], v[184:187], v[196:199], v[32:47]
    v_mfma_f32_32x32x16_bf16 v[48:63], v[192:195], v[188:191], v[48:63]
    v_mfma_f32_32x32x16_bf16 v[64:79], v[192:195], v[196:199], v[64:79]
    v_mfma_f32_32x32x16_bf16 v[16:31], v[184:187], v[188:191], v[16:31]
    v_add_u32 v11, s6, v2
    s_add_u32 s6, s6, 1024
    s_cmp_eq_u32 s6, 114688
    s_cselect_b32 s6, 0, s6
    buffer_load_dwordx4 v[184:187], v11, s[40:43], s9 offen
    buffer_load_dwordx4 v[188:191], v11, s[40:43], s7 offen
    buffer_load_dwordx4 v[192:195], v11, s[40:43], s10 offen
    buffer_load_dwordx4 v[196:199], v11, s[40:43], s8 offen
    s_waitcnt vmcnt(28)
    v_mfma_f32_32x32x16_bf16 v[32:47], v[200:203], v[212:215], v[32:47]
    v_mfma_f32_32x32x16_bf16 v[48:63], v[208:211], v[204:207], v[48:63]
    v_mfma_f32_32x32x16_bf16 v[64:79], v[208:211], v[212:215], v[64:79]
    v_mfma_f32_32x32x16_bf16 v[16:31], v[200:203], v[204:207], v[16:31]
    v_add_u32 v12, s6, v2
    s_add_u32 s6, s6, 1024
    s_cmp_eq_u32 s6, 114688
    s_cselect_b32 s6, 0, s6
    buffer_load_dwordx4 v[200:203], v12, s[40:43], s9 offen
    buffer_load_dwordx4 v[204:207], v12, s[40:43], s7 offen
    buffer_load_dwordx4 v[208:211], v12, s[40:43], s10 offen
    buffer_load_dwordx4 v[212:215], v12, s[40:43], s8 offen
    s_waitcnt vmcnt(28)
    v_mfma_f32_32x32x16_bf16 v[32:47], v[216:219], v[228:231], v[32:47]
    v_mfma_f32_32x32x16_bf16 v[48:63], v[224:227], v[220:223], v[48:63]
    v_mfma_f32_32x32x16_bf16 v[64:79], v[224:227], v[228:231], v[64:79]
    v_mfma_f32_32x32x16_bf16 v[16:31], v[216:219], v[220:223], v[16:31]
    v_add_u32 v11, s6, v2
    s_add_u32 s6, s6, 1024
    s_cmp_eq_u32 s6, 114688
    s_cselect_b32 s6, 0, s6
    buffer_load_dwordx4 v[216:219], v11, s[40:43], s9 offen
    buffer_load_dwordx4 v[220:223], v11, s[40:43], s7 offen
    buffer_load_dwordx4 v[224:227], v11, s[40:43], s10 offen
    buffer_load_dwordx4 v[228:231], v11, s[40:43], s8 offen
    s_waitcnt vmcnt(28)
    v_mfma_f32_32x32x16_bf16 v[32:47], v[104:107], v[116:119], v[32:47]
    v_mfma_f32_32x32x16_bf16 v[48:63], v[112:115], v[108:111], v[48:63]
    v_mfma_f32_32x32x16_bf16 v[64:79], v[112:115], v[116:119], v[64:79]
    v_mfma_f32_32x32x16_bf16 v[16:31], v[104:107], v[108:111], v[16:31]
    v_add_u32 v12, s6, v2
    s_add_u32 s6, s6, 1024
    s_cmp_eq_u32 s6, 114688
    s_cselect_b32 s6, 0, s6
    buffer_load_dwordx4 v[104:107], v12, s[40:43], s9 offen
    buffer_load_dwordx4 v[108:111], v12, s[40:43], s7 offen
    buffer_load_dwordx4 v[112:115], v12, s[40:43], s10 offen
    buffer_load_dwordx4 v[116:119], v12, s[40:43], s8 offen
    s_waitcnt vmcnt(28)
    v_mfma_f32_32x32x16_bf16 v[32:47], v[120:123], v[132:135], v[32:47]
    v_mfma_f32_32x32x16_bf16 v[48:63], v[128:131], v[124:127], v[48:63]
    v_mfma_f32_32x32x16_bf16 v[64:79], v[128:131], v[132:135], v[64:79]
    v_mfma_f32_32x32x16_bf16 v[16:31], v[120:123], v[124:127], v[16:31]
    v_add_u32 v11, s6, v2
    s_add_u32 s6, s6, 1024
    s_cmp_eq_u32 s6, 114688
    s_cselect_b32 s6, 0, s6
    buffer_load_dwordx4 v[120:123], v11, s[40:43], s9 offen
    buffer_load_dwordx4 v[124:127], v11, s[40:43], s7 offen
    buffer_load_dwordx4 v[128:131], v11, s[40:43], s10 offen
    buffer_load_dwordx4 v[132:135], v11, s[40:43], s8 offen
    s_waitcnt vmcnt(28)
    v_mfma_f32_32x32x16_bf16 v[32:47], v[136:139], v[148:151], v[32:47]
    v_mfma_f32_32x32x16_bf16 v[48:63], v[144:147], v[140:143], v[48:63]
    v_mfma_f32_32x32x16_bf16 v[64:79], v[144:147], v[148:151], v[64:79]
    v_mfma_f32_32x32x16_bf16 v[16:31], v[136:139], v[140:143], v[16:31]
    v_add_u32 v12, s6, v2
    s_add_u32 s6, s6, 1024
    s_cmp_eq_u32 s6, 114688
    s_cselect_b32 s6, 0, s6
    buffer_load_dwordx4 v[136:139], v12, s[40:43], s9 offen
    buffer_load_dwordx4 v[140:143], v12, s[40:43], s7 offen
    buffer_load_dwordx4 v[144:147], v12, s[40:43], s10 offen
    buffer_load_dwordx4 v[148:151], v12, s[40:43], s8 offen
    s_waitcnt vmcnt(28)
    v_mfma_f32_32x32x16_bf16 v[32:47], v[152:155], v[164:167], v[32:47]
    v_mfma_f32_32x32x16_bf16 v[48:63], v[160:163], v[156:159], v[48:63]
    v_mfma_f32_32x32x16_bf16 v[64:79], v[160:163], v[164:167], v[64:79]
    v_mfma_f32_32x32x16_bf16 v[16:31], v[152:155], v[156:159], v[16:31]
    v_add_u32 v11, s6, v2
    s_add_u32 s6, s6, 1024
    s_cmp_eq_u32 s6, 114688
    s_cselect_b32 s6, 0, s6
    buffer_load_dwordx4 v[152:155], v11, s[40:43], s9 offen
    buffer_load_dwordx4 v[156:159], v11, s[40:43], s7 offen
    buffer_load_dwordx4 v[160:163], v11, s[40:43], s10 offen
    buffer_load_dwordx4 v[164:167], v11, s[40:43], s8 offen
    s_lshl_b32 s15, s14, 7
    s_add_u32 s15, s15, 10096640
    v_lshlrev_b32 v5, 5, v3
    buffer_load_dwordx4 v[80:83], v5, s[40:43], s15 offen offset:0
    buffer_load_dwordx4 v[84:87], v5, s[40:43], s15 offen offset:16
    buffer_load_dwordx4 v[88:91], v5, s[40:43], s15 offen offset:64
    buffer_load_dwordx4 v[92:95], v5, s[40:43], s15 offen offset:80
    s_lshl_b32 s15, s13, 15
    s_lshl_b32 s60, s14, 11
    s_add_u32 s15, s15, s60
    s_add_u32 s15, s15, 22020096
    buffer_load_dwordx4 v[96:99], v2, s[40:43], s15 offen offset:0
    buffer_load_dwordx4 v[100:103], v2, s[40:43], s15 offen offset:1024
    s_waitcnt vmcnt(34)
    v_mfma_f32_32x32x16_bf16 v[32:47], v[168:171], v[180:183], v[32:47]
    v_mfma_f32_32x32x16_bf16 v[48:63], v[176:179], v[172:175], v[48:63]
    v_mfma_f32_32x32x16_bf16 v[64:79], v[176:179], v[180:183], v[64:79]
    v_mfma_f32_32x32x16_bf16 v[16:31], v[168:171], v[172:175], v[16:31]
    s_waitcnt vmcnt(30)
    v_mfma_f32_32x32x16_bf16 v[32:47], v[184:187], v[196:199], v[32:47]
    v_mfma_f32_32x32x16_bf16 v[48:63], v[192:195], v[188:191], v[48:63]
    v_mfma_f32_32x32x16_bf16 v[64:79], v[192:195], v[196:199], v[64:79]
    v_mfma_f32_32x32x16_bf16 v[16:31], v[184:187], v[188:191], v[16:31]
    s_waitcnt vmcnt(26)
    v_mfma_f32_32x32x16_bf16 v[32:47], v[200:203], v[212:215], v[32:47]
    v_mfma_f32_32x32x16_bf16 v[48:63], v[208:211], v[204:207], v[48:63]
    v_mfma_f32_32x32x16_bf16 v[64:79], v[208:211], v[212:215], v[64:79]
    v_mfma_f32_32x32x16_bf16 v[16:31], v[200:203], v[204:207], v[16:31]
    s_waitcnt vmcnt(22)
    v_mfma_f32_32x32x16_bf16 v[32:47], v[216:219], v[228:231], v[32:47]
    v_mfma_f32_32x32x16_bf16 v[48:63], v[224:227], v[220:223], v[48:63]
    v_mfma_f32_32x32x16_bf16 v[64:79], v[224:227], v[228:231], v[64:79]
    v_mfma_f32_32x32x16_bf16 v[16:31], v[216:219], v[220:223], v[16:31]
    s_waitcnt vmcnt(18)
    v_mfma_f32_32x32x16_bf16 v[32:47], v[104:107], v[116:119], v[32:47]
    v_mfma_f32_32x32x16_bf16 v[48:63], v[112:115], v[108:111], v[48:63]
    v_mfma_f32_32x32x16_bf16 v[64:79], v[112:115], v[116:119], v[64:79]
    v_mfma_f32_32x32x16_bf16 v[16:31], v[104:107], v[108:111], v[16:31]
    s_waitcnt vmcnt(14)
    v_mfma_f32_32x32x16_bf16 v[32:47], v[120:123], v[132:135], v[32:47]
    v_mfma_f32_32x32x16_bf16 v[48:63], v[128:131], v[124:127], v[48:63]
    v_mfma_f32_32x32x16_bf16 v[64:79], v[128:131], v[132:135], v[64:79]
    v_mfma_f32_32x32x16_bf16 v[16:31], v[120:123], v[124:127], v[16:31]
    s_waitcnt vmcnt(10)
    v_mfma_f32_32x32x16_bf16 v[32:47], v[136:139], v[148:151], v[32:47]
    v_mfma_f32_32x32x16_bf16 v[48:63], v[144:147], v[140:143], v[48:63]
    v_mfma_f32_32x32x16_bf16 v[64:79], v[144:147], v[148:151], v[64:79]
    v_mfma_f32_32x32x16_bf16 v[16:31], v[136:139], v[140:143], v[16:31]
    s_waitcnt vmcnt(6)
    v_mfma_f32_32x32x16_bf16 v[32:47], v[152:155], v[164:167], v[32:47]
    v_mfma_f32_32x32x16_bf16 v[48:63], v[160:163], v[156:159], v[48:63]
    v_mfma_f32_32x32x16_bf16 v[64:79], v[160:163], v[164:167], v[64:79]
    v_mfma_f32_32x32x16_bf16 v[16:31], v[152:155], v[156:159], v[16:31]
    s_xor_b32 s15, s3, 2
    s_mul_i32 s15, s15, 12288
    v_add_u32 v8, s15, v2
    s_xor_b32 s15, s3, 1
    s_mul_i32 s15, s15, 12288
    v_add_u32 v9, s15, v2
    s_xor_b32 s15, s3, 3
    s_mul_i32 s15, s15, 12288
    v_add_u32 v10, s15, v2
    ds_write_b128 v8, v[32:35] offset:0
    ds_write_b128 v8, v[36:39] offset:1024
    ds_write_b128 v8, v[40:43] offset:2048
    ds_write_b128 v8, v[44:47] offset:3072
    ds_write_b128 v9, v[48:51] offset:4096
    ds_write_b128 v9, v[52:55] offset:5120
    ds_write_b128 v9, v[56:59] offset:6144
    ds_write_b128 v9, v[60:63] offset:7168
    ds_write_b128 v10, v[64:67] offset:8192
    ds_write_b128 v10, v[68:71] offset:9216
    ds_write_b128 v10, v[72:75] offset:10240
    ds_write_b128 v10, v[76:79] offset:11264
    s_mul_i32 s15, s3, 12288
    v_add_u32 v7, s15, v2
    s_waitcnt lgkmcnt(0)
    s_barrier
    ds_read_b128 v[32:35], v7 offset:0
    ds_read_b128 v[36:39], v7 offset:1024
    ds_read_b128 v[40:43], v7 offset:2048
    ds_read_b128 v[44:47], v7 offset:3072
    ds_read_b128 v[48:51], v7 offset:4096
    ds_read_b128 v[52:55], v7 offset:5120
    ds_read_b128 v[56:59], v7 offset:6144
    ds_read_b128 v[60:63], v7 offset:7168
    ds_read_b128 v[64:67], v7 offset:8192
    ds_read_b128 v[68:71], v7 offset:9216
    ds_read_b128 v[72:75], v7 offset:10240
    ds_read_b128 v[76:79], v7 offset:11264
    s_waitcnt lgkmcnt(8)
    v_add_f32 v16, v16, v32
    v_add_f32 v17, v17, v33
    v_add_f32 v18, v18, v34
    v_add_f32 v19, v19, v35
    v_add_f32 v20, v20, v36
    v_add_f32 v21, v21, v37
    v_add_f32 v22, v22, v38
    v_add_f32 v23, v23, v39
    v_add_f32 v24, v24, v40
    v_add_f32 v25, v25, v41
    v_add_f32 v26, v26, v42
    v_add_f32 v27, v27, v43
    v_add_f32 v28, v28, v44
    v_add_f32 v29, v29, v45
    v_add_f32 v30, v30, v46
    v_add_f32 v31, v31, v47
    s_waitcnt lgkmcnt(4)
    v_add_f32 v16, v16, v48
    v_add_f32 v17, v17, v49
    v_add_f32 v18, v18, v50
    v_add_f32 v19, v19, v51
    v_add_f32 v20, v20, v52
    v_add_f32 v21, v21, v53
    v_add_f32 v22, v22, v54
    v_add_f32 v23, v23, v55
    v_add_f32 v24, v24, v56
    v_add_f32 v25, v25, v57
    v_add_f32 v26, v26, v58
    v_add_f32 v27, v27, v59
    v_add_f32 v28, v28, v60
    v_add_f32 v29, v29, v61
    v_add_f32 v30, v30, v62
    v_add_f32 v31, v31, v63
    s_waitcnt lgkmcnt(0)
    v_add_f32 v16, v16, v64
    v_add_f32 v17, v17, v65
    v_add_f32 v18, v18, v66
    v_add_f32 v19, v19, v67
    v_add_f32 v20, v20, v68
    v_add_f32 v21, v21, v69
    v_add_f32 v22, v22, v70
    v_add_f32 v23, v23, v71
    v_add_f32 v24, v24, v72
    v_add_f32 v25, v25, v73
    v_add_f32 v26, v26, v74
    v_add_f32 v27, v27, v75
    v_add_f32 v28, v28, v76
    v_add_f32 v29, v29, v77
    v_add_f32 v30, v30, v78
    v_add_f32 v31, v31, v79
    s_waitcnt vmcnt(0)
    v_lshlrev_b32 v48, 16, v96
    v_and_b32 v49, 4294901760, v96
    v_lshlrev_b32 v50, 16, v97
    v_and_b32 v51, 4294901760, v97
    v_lshlrev_b32 v52, 16, v98
    v_and_b32 v53, 4294901760, v98
    v_lshlrev_b32 v54, 16, v99
    v_and_b32 v55, 4294901760, v99
    v_lshlrev_b32 v56, 16, v100
    v_and_b32 v57, 4294901760, v100
    v_lshlrev_b32 v58, 16, v101
    v_and_b32 v59, 4294901760, v101
    v_lshlrev_b32 v60, 16, v102
    v_and_b32 v61, 4294901760, v102
    v_lshlrev_b32 v62, 16, v103
    v_and_b32 v63, 4294901760, v103
    v_fmac_f32 v48, v16, v80
    v_fmac_f32 v49, v17, v81
    v_fmac_f32 v50, v18, v82
    v_fmac_f32 v51, v19, v83
    v_fmac_f32 v52, v20, v84
    v_fmac_f32 v53, v21, v85
    v_fmac_f32 v54, v22, v86
    v_fmac_f32 v55, v23, v87
    v_fmac_f32 v56, v24, v88
    v_fmac_f32 v57, v25, v89
    v_fmac_f32 v58, v26, v90
    v_fmac_f32 v59, v27, v91
    v_fmac_f32 v60, v28, v92
    v_fmac_f32 v61, v29, v93
    v_fmac_f32 v62, v30, v94
    v_fmac_f32 v63, v31, v95
    v_cvt_pk_bf16_f32 v32, v48, v49
    v_cvt_pk_bf16_f32 v33, v50, v51
    v_cvt_pk_bf16_f32 v34, v52, v53
    v_cvt_pk_bf16_f32 v35, v54, v55
    v_cvt_pk_bf16_f32 v36, v56, v57
    v_cvt_pk_bf16_f32 v37, v58, v59
    v_cvt_pk_bf16_f32 v38, v60, v61
    v_cvt_pk_bf16_f32 v39, v62, v63
    s_mov_b32 s44, s34
    s_mov_b32 s45, s35
    s_mov_b32 s46, 2097152
    s_mov_b32 s47, 131072
    s_lshl_b32 s15, s13, 15
    s_lshl_b32 s60, s14, 6
    s_add_u32 s15, s15, s60
    v_lshlrev_b32 v6, 10, v4
    v_lshl_add_u32 v6, v3, 4, v6
    buffer_store_dwordx4 v[32:35], v6, s[44:47], s15 offen offset:0
    buffer_store_dwordx4 v[36:39], v6, s[44:47], s15 offen offset:32
    s_nop 1
L_end_k5_down_kernel:
    s_endpgm

L_code_end:
.section .rodata,"a"
.p2align 6
.amdhsa_kernel k0_mod_kernel
  .amdhsa_next_free_vgpr 116
  .amdhsa_next_free_sgpr 67
  .amdhsa_accum_offset 116
  .amdhsa_group_segment_fixed_size 0
  .amdhsa_kernarg_size 96
  .amdhsa_user_sgpr_count 2
  .amdhsa_user_sgpr_kernarg_segment_ptr 1
  .amdhsa_system_sgpr_workgroup_id_x 1
.end_amdhsa_kernel

.p2align 6
.amdhsa_kernel k1_qkv_kernel
  .amdhsa_next_free_vgpr 197
  .amdhsa_next_free_sgpr 64
  .amdhsa_accum_offset 200
  .amdhsa_group_segment_fixed_size 0
  .amdhsa_kernarg_size 96
  .amdhsa_user_sgpr_count 2
  .amdhsa_user_sgpr_kernarg_segment_ptr 1
  .amdhsa_system_sgpr_workgroup_id_x 1
.end_amdhsa_kernel

.p2align 6
.amdhsa_kernel k2_attn_kernel
  .amdhsa_next_free_vgpr 250
  .amdhsa_next_free_sgpr 70
  .amdhsa_accum_offset 252
  .amdhsa_group_segment_fixed_size 0
  .amdhsa_kernarg_size 96
  .amdhsa_user_sgpr_count 2
  .amdhsa_user_sgpr_kernarg_segment_ptr 1
  .amdhsa_system_sgpr_workgroup_id_x 1
.end_amdhsa_kernel

.p2align 6
.amdhsa_kernel k3_wo_kernel
  .amdhsa_next_free_vgpr 240
  .amdhsa_next_free_sgpr 63
  .amdhsa_accum_offset 240
  .amdhsa_group_segment_fixed_size 0
  .amdhsa_kernarg_size 96
  .amdhsa_user_sgpr_count 2
  .amdhsa_user_sgpr_kernarg_segment_ptr 1
  .amdhsa_system_sgpr_workgroup_id_x 1
.end_amdhsa_kernel

.p2align 6
.amdhsa_kernel k4_ffn1_kernel
  .amdhsa_next_free_vgpr 256
  .amdhsa_next_free_sgpr 64
  .amdhsa_accum_offset 128
  .amdhsa_group_segment_fixed_size 0
  .amdhsa_kernarg_size 96
  .amdhsa_user_sgpr_count 2
  .amdhsa_user_sgpr_kernarg_segment_ptr 1
  .amdhsa_system_sgpr_workgroup_id_x 1
.end_amdhsa_kernel

.p2align 6
.amdhsa_kernel k5_down_kernel
  .amdhsa_next_free_vgpr 232
  .amdhsa_next_free_sgpr 63
  .amdhsa_accum_offset 232
  .amdhsa_group_segment_fixed_size 0
  .amdhsa_kernarg_size 96
  .amdhsa_user_sgpr_count 2
  .amdhsa_user_sgpr_kernarg_segment_ptr 1
  .amdhsa_system_sgpr_workgroup_id_x 1
.end_amdhsa_kernel
```
